```python
import torch

def _softmax(x, axis=-1):
    return torch.softmax(x, dim=axis)
def _gelu(x):
    return torch.nn.functional.gelu(x, approximate="tanh")
def _silu(x):
    return torch.nn.functional.silu(x)
def _sigmoid(x):
    return torch.sigmoid(x)
def _layernorm(x, axis=-1, eps=1e-5):
    m = x.mean(dim=axis, keepdim=True)
    v = x.var(dim=axis, keepdim=True, unbiased=False)
    return (x - m) / torch.sqrt(v + eps)
def _scatter_add(tgt, idx, src, axis=0):
    return tgt.clone().index_add_(axis, idx, src)
def _segment_sum(src, seg, n):
    out = torch.zeros((n,) + src.shape[1:], dtype=src.dtype)
    return out.index_add_(0, seg, src)
def _pad(x, pw):
    flat = tuple(v for pair in reversed(pw) for v in pair)
    return torch.nn.functional.pad(x, flat)

kernel_name = 'concat_heads__compressed_kv_cla__compressed_kv_cla__decode'

def setup_inputs():

    _w = (lambda a: (lambda t: t.to(torch.bfloat16) if t.is_floating_point() else t)(torch.as_tensor(a)))
    def _A_setup():
        B, H, Sq, Sk, D, M = 4, 32, 1, 4096, 128, 512
        Dc = 4 * D
        return {
            "x": _w((lambda *s: torch.randn(*s, dtype=torch.bfloat16) * 3.2)(B, Sq, M)),
            "c_kv": _w((lambda *s: torch.randn(*s, dtype=torch.bfloat16) * 0.05)(B, Sk, Dc)),
            "w_q": _w((lambda *s: torch.randn(*s, dtype=torch.bfloat16) * 3.2)(M, H, D) * (M ** -0.5)),
            "w_uk": _w((lambda *s: torch.randn(*s, dtype=torch.bfloat16) * 3.2)(Dc, H, D) * (Dc ** -0.5)),
            "w_uv": _w((lambda *s: torch.randn(*s, dtype=torch.bfloat16) * 0.05)(Dc, H, D) * (Dc ** -0.5)),
            "w_o": _w((lambda *s: torch.randn(*s, dtype=torch.bfloat16) * 0.05)(H, D, M) * ((H * D) ** -0.5)),
        }
    _A_in = _A_setup()

    def _B_setup():
        B, H, Sq, Sk, D, M = 4, 32, 1, 4096, 128, 512
        Dc = 4 * D
        return {
            "x": _w((lambda *s: torch.randn(*s, dtype=torch.bfloat16) * 3.2)(B, Sq, M)),
            "c_kv": _w((lambda *s: torch.randn(*s, dtype=torch.bfloat16) * 0.05)(B, Sk, Dc)),
            "w_q": _w((lambda *s: torch.randn(*s, dtype=torch.bfloat16) * 3.2)(M, H, D) * (M ** -0.5)),
            "w_uk": _w((lambda *s: torch.randn(*s, dtype=torch.bfloat16) * 3.2)(Dc, H, D) * (Dc ** -0.5)),
            "w_uv": _w((lambda *s: torch.randn(*s, dtype=torch.bfloat16) * 0.05)(Dc, H, D) * (Dc ** -0.5)),
            "w_o": _w((lambda *s: torch.randn(*s, dtype=torch.bfloat16) * 0.05)(H, D, M) * ((H * D) ** -0.5)),
        }
    _B_in = _B_setup()

    return {
        "A_x": _A_in["x"],
        "A_c_kv": _A_in["c_kv"],
        "A_w_q": _A_in["w_q"],
        "A_w_uk": _A_in["w_uk"],
        "A_w_uv": _A_in["w_uv"],
        "A_w_o": _A_in["w_o"],
        "B_x": _B_in["x"],
        "B_c_kv": _B_in["c_kv"],
        "B_w_q": _B_in["w_q"],
        "B_w_uk": _B_in["w_uk"],
        "B_w_uv": _B_in["w_uv"],
        "B_w_o": _B_in["w_o"],
    }

def reference(A_x, A_c_kv, A_w_q, A_w_uk, A_w_uv, A_w_o, B_x, B_c_kv, B_w_q, B_w_uk, B_w_uv, B_w_o):
    def _A_ref(x, c_kv, w_q, w_uk, w_uv, w_o):
        B, Sq, M = x.shape[0], x.shape[1], x.shape[2]
        Sk = c_kv.shape[1]
        H, D = w_q.shape[1], w_q.shape[2]
        q = torch.einsum("bqm,mhd->bhqd", x, w_q)
        k = torch.einsum("bkc,chd->bhkd", c_kv, w_uk)
        v = torch.einsum("bkc,chd->bhkd", c_kv, w_uv)
        scores = torch.einsum("bhqd,bhkd->bhqk", q, k) * (D ** -0.5)
        off = Sk - Sq
        qi = torch.arange(Sq)[:, None]
        kj = torch.arange(Sk)[None, :]
        cmask = kj <= (qi + off)
        scores = torch.where(cmask[None, None], scores, -1e9)
        p = _softmax(scores, axis=-1)
        ctx = torch.einsum("bhqk,bhkd->bhqd", p, v)
        return torch.einsum("bhqd,hdm->bqm", ctx, w_o)

    def _B_ref(x, c_kv, w_q, w_uk, w_uv, w_o):
        B, Sq, M = x.shape[0], x.shape[1], x.shape[2]
        Sk = c_kv.shape[1]
        H, D = w_q.shape[1], w_q.shape[2]
        q = torch.einsum("bqm,mhd->bhqd", x, w_q)
        k = torch.einsum("bkc,chd->bhkd", c_kv, w_uk)
        v = torch.einsum("bkc,chd->bhkd", c_kv, w_uv)
        scores = torch.einsum("bhqd,bhkd->bhqk", q, k) * (D ** -0.5)
        off = Sk - Sq
        qi = torch.arange(Sq)[:, None]
        kj = torch.arange(Sk)[None, :]
        cmask = kj <= (qi + off)
        scores = torch.where(cmask[None, None], scores, -1e9)
        p = _softmax(scores, axis=-1)
        ctx = torch.einsum("bhqk,bhkd->bhqd", p, v)
        return torch.einsum("bhqd,hdm->bqm", ctx, w_o)

    a = _A_ref(A_x, A_c_kv, A_w_q, A_w_uk, A_w_uv, A_w_o)
    b = _B_ref(B_x, B_c_kv, B_w_q, B_w_uk, B_w_uv, B_w_o)
    return torch.concatenate([a, b], axis=-1)
```

```asm
; @launch grid=(256,1,1) block=(512,1,1) lds=163840
.amdgcn_target "amdgcn-amd-amdhsa--gfx950"
.text
.globl concat_heads__compressed_kv_cla__compressed_kv_cla__decode_kernel
.p2align 8
.type concat_heads__compressed_kv_cla__compressed_kv_cla__decode_kernel,@function
concat_heads__compressed_kv_cla__compressed_kv_cla__decode_kernel:
    s_cmp_ge_u32 s2, 256
    s_cbranch_scc1 L_end
    s_load_dwordx16 s[4:19], s[0:1], 0
    s_load_dwordx8 s[20:27], s[0:1], 64
    s_load_dwordx4 s[28:31], s[0:1], 96
    s_load_dwordx2 s[32:33], s[0:1], 112
    v_lshrrev_b32 v6, 6, v0
    v_and_b32 v1, 63, v0
    v_and_b32 v2, 15, v0
    v_readfirstlane_b32 s75, v6
    v_lshrrev_b32 v3, 4, v1
    s_and_b32 s72, s2, 31
    s_bfe_u32 s73, s2, 0x10005
    s_lshr_b32 s74, s2, 6
    s_bfe_u32 s96, s2, 0x10002
    s_and_b32 s97, s2, 3
    s_lshr_b32 s98, s2, 3
    s_and_b32 s76, s75, 3
    s_mov_b32 s81, 0x05040100
    s_mov_b32 s82, 0x07060302
    s_mov_b32 s83, 0x3e0293ee
    s_mov_b32 s84, 0x400000
    v_lshlrev_b32 v7, 2, v0
    v_add_u32 v7, 161792, v7
    v_mov_b32 v8, 0
    ds_write_b32 v7, v8
    v_mov_b32 v5, 161792
    v_lshlrev_b32 v6, 2, v6
    v_add_u32 v4, 161792, v6
    s_waitcnt lgkmcnt(0)
    s_cmp_eq_u32 s73, 0
    s_cselect_b64 s[36:37], s[4:5], s[16:17]
    s_cselect_b64 s[40:41], s[6:7], s[18:19]
    s_cselect_b64 s[44:45], s[8:9], s[20:21]
    s_cselect_b64 s[48:49], s[10:11], s[22:23]
    s_cselect_b64 s[52:53], s[12:13], s[24:25]
    s_cselect_b64 s[56:57], s[14:15], s[26:27]
    s_cmp_eq_u32 s96, 0
    s_cselect_b64 s[40:41], s[6:7], s[18:19]
    s_and_b32 s37, s37, 0xffff
    s_mov_b32 s38, 4096
    s_mov_b32 s39, 0x00020000
    s_and_b32 s41, s41, 0xffff
    s_mov_b32 s42, 16777216
    s_mov_b32 s43, 0x00020000
    s_and_b32 s45, s45, 0xffff
    s_mov_b32 s46, 4194304
    s_mov_b32 s47, 0x00020000
    s_and_b32 s49, s49, 0xffff
    s_mov_b32 s50, 4194304
    s_mov_b32 s51, 0x00020000
    s_and_b32 s53, s53, 0xffff
    s_mov_b32 s54, 4194304
    s_mov_b32 s55, 0x00020000
    s_and_b32 s57, s57, 0xffff
    s_mov_b32 s58, 4194304
    s_mov_b32 s59, 0x00020000
    s_mov_b32 s60, s28
    s_and_b32 s61, s29, 0xffff
    s_mov_b32 s62, 8192
    s_mov_b32 s63, 0x00020000
    s_mov_b32 s64, s30
    s_and_b32 s65, s31, 0xffff
    s_mov_b32 s66, 256
    s_mov_b32 s67, 0x00020000
    s_mov_b32 s68, s32
    s_and_b32 s69, s33, 0xffff
    s_mov_b32 s70, 268435456
    s_mov_b32 s71, 0x00020000
    s_barrier
    s_cmp_ge_u32 s75, 4
    s_cbranch_scc1 L_B
    v_mov_b32 v12, 0
    s_or_b32 s77, s2, s75
    s_cmp_lg_u32 s77, 0
    s_cbranch_scc1 L_nonon_1
    s_memrealtime s[94:95]
    s_waitcnt lgkmcnt(0)
    s_or_b32 s77, s94, 1
    v_mov_b32 v6, s77
    s_mov_b64 exec, 1
    buffer_store_dword v6, v12, s[64:67], 0 offen sc1
    s_mov_b64 exec, -1
L_nonon_1:
    s_lshl_b32 s77, s76, 8
    v_lshlrev_b32 v8, 10, v2
    v_lshl_add_u32 v8, v3, 4, v8
    v_add_u32 v8, s77, v8
    s_lshl_b32 s77, s76, 20
    v_lshlrev_b32 v9, 16, v3
    v_lshl_add_u32 v9, v2, 4, v9
    v_add_u32 v9, s77, v9
    s_lshl_b32 s77, s76, 18
    v_lshlrev_b32 v10, 13, v2
    v_lshl_add_u32 v10, v3, 4, v10
    v_add_u32 v10, s77, v10
    v_lshlrev_b32 v11, 4, v0
    v_lshlrev_b32 v13, 4, v1
    s_lshl_b32 s78, s72, 8
    s_add_u32 s77, s74, 0
    s_and_b32 s77, s77, 3
    s_lshl_b32 s90, s77, 6
    s_lshl_b32 s86, s77, 18
    s_add_u32 s86, s86, s78
    s_add_u32 s77, s74, 1
    s_and_b32 s77, s77, 3
    s_lshl_b32 s91, s77, 6
    s_lshl_b32 s87, s77, 18
    s_add_u32 s87, s87, s78
    s_add_u32 s77, s74, 2
    s_and_b32 s77, s77, 3
    s_lshl_b32 s92, s77, 6
    s_lshl_b32 s88, s77, 18
    s_add_u32 s88, s88, s78
    s_add_u32 s77, s74, 3
    s_and_b32 s77, s77, 3
    s_lshl_b32 s93, s77, 6
    s_lshl_b32 s89, s77, 18
    s_add_u32 s89, s89, s78
    buffer_load_dwordx4 v[32:35], v8, s[36:39], s90 offen
    buffer_load_dwordx4 v[36:39], v8, s[36:39], s91 offen
    buffer_load_dwordx4 v[40:43], v8, s[36:39], s92 offen
    buffer_load_dwordx4 v[44:47], v8, s[36:39], s93 offen
    s_add_u32 s77, s86, 0
    buffer_load_dwordx4 v[48:51], v9, s[44:47], s77 offen
    s_add_u32 s77, s86, 8192
    buffer_load_dwordx4 v[52:55], v9, s[44:47], s77 offen
    s_add_u32 s77, s86, 16384
    buffer_load_dwordx4 v[56:59], v9, s[44:47], s77 offen
    s_add_u32 s77, s86, 24576
    buffer_load_dwordx4 v[60:63], v9, s[44:47], s77 offen
    s_add_u32 s77, s86, 32768
    buffer_load_dwordx4 v[64:67], v9, s[44:47], s77 offen
    s_add_u32 s77, s86, 40960
    buffer_load_dwordx4 v[68:71], v9, s[44:47], s77 offen
    s_add_u32 s77, s86, 49152
    buffer_load_dwordx4 v[72:75], v9, s[44:47], s77 offen
    s_add_u32 s77, s86, 57344
    buffer_load_dwordx4 v[76:79], v9, s[44:47], s77 offen
    s_add_u32 s77, s87, 0
    buffer_load_dwordx4 v[80:83], v9, s[44:47], s77 offen
    s_add_u32 s77, s87, 8192
    buffer_load_dwordx4 v[84:87], v9, s[44:47], s77 offen
    s_add_u32 s77, s87, 16384
    buffer_load_dwordx4 v[88:91], v9, s[44:47], s77 offen
    s_add_u32 s77, s87, 24576
    buffer_load_dwordx4 v[92:95], v9, s[44:47], s77 offen
    s_add_u32 s77, s87, 32768
    buffer_load_dwordx4 v[96:99], v9, s[44:47], s77 offen
    s_add_u32 s77, s87, 40960
    buffer_load_dwordx4 v[100:103], v9, s[44:47], s77 offen
    s_add_u32 s77, s87, 49152
    buffer_load_dwordx4 v[104:107], v9, s[44:47], s77 offen
    s_add_u32 s77, s87, 57344
    buffer_load_dwordx4 v[108:111], v9, s[44:47], s77 offen
    s_add_u32 s77, s88, 0
    buffer_load_dwordx4 v[112:115], v9, s[44:47], s77 offen
    s_add_u32 s77, s88, 8192
    buffer_load_dwordx4 v[116:119], v9, s[44:47], s77 offen
    s_add_u32 s77, s88, 16384
    buffer_load_dwordx4 v[120:123], v9, s[44:47], s77 offen
    s_add_u32 s77, s88, 24576
    buffer_load_dwordx4 v[124:127], v9, s[44:47], s77 offen
    s_add_u32 s77, s88, 32768
    buffer_load_dwordx4 v[128:131], v9, s[44:47], s77 offen
    s_add_u32 s77, s88, 40960
    buffer_load_dwordx4 v[132:135], v9, s[44:47], s77 offen
    s_add_u32 s77, s88, 49152
    buffer_load_dwordx4 v[136:139], v9, s[44:47], s77 offen
    s_add_u32 s77, s88, 57344
    buffer_load_dwordx4 v[140:143], v9, s[44:47], s77 offen
    s_add_u32 s77, s89, 0
    buffer_load_dwordx4 v[144:147], v9, s[44:47], s77 offen
    s_add_u32 s77, s89, 8192
    buffer_load_dwordx4 v[148:151], v9, s[44:47], s77 offen
    s_add_u32 s77, s89, 16384
    buffer_load_dwordx4 v[152:155], v9, s[44:47], s77 offen
    s_add_u32 s77, s89, 24576
    buffer_load_dwordx4 v[156:159], v9, s[44:47], s77 offen
    s_add_u32 s77, s89, 32768
    buffer_load_dwordx4 v[160:163], v9, s[44:47], s77 offen
    s_add_u32 s77, s89, 40960
    buffer_load_dwordx4 v[164:167], v9, s[44:47], s77 offen
    s_add_u32 s77, s89, 49152
    buffer_load_dwordx4 v[168:171], v9, s[44:47], s77 offen
    s_add_u32 s77, s89, 57344
    buffer_load_dwordx4 v[172:175], v9, s[44:47], s77 offen
    s_lshl_b32 s77, s74, 20
    s_add_u32 s77, s77, s78
    s_add_u32 s79, s77, 131072
    buffer_load_dwordx4 v[176:179], v10, s[48:51], s77 offen offset:0
    buffer_load_dwordx4 v[180:183], v10, s[48:51], s77 offen offset:64
    buffer_load_dwordx4 v[184:187], v10, s[48:51], s77 offen offset:128
    buffer_load_dwordx4 v[188:191], v10, s[48:51], s77 offen offset:192
    buffer_load_dwordx4 v[192:195], v10, s[48:51], s79 offen offset:0
    buffer_load_dwordx4 v[196:199], v10, s[48:51], s79 offen offset:64
    buffer_load_dwordx4 v[200:203], v10, s[48:51], s79 offen offset:128
    buffer_load_dwordx4 v[204:207], v10, s[48:51], s79 offen offset:192
    s_lshl_b32 s77, s73, 7
    s_lshl_b32 s78, s74, 5
    s_add_u32 s77, s77, s78
    s_add_u32 s77, s77, s72
    s_lshl_b32 s77, s77, 13
    s_add_u32 s90, s77, 16777216
    s_add_u32 s91, s90, 4096
    v_add_u32 v14, 16, v4
    buffer_load_dword v30, v12, s[64:67], 0 offen sc1
    s_waitcnt vmcnt(33)
    v_perm_b32 v240, v52, v48, s81
    v_perm_b32 v241, v60, v56, s81
    v_perm_b32 v242, v68, v64, s81
    v_perm_b32 v243, v76, v72, s81
    v_perm_b32 v244, v52, v48, s82
    v_perm_b32 v245, v60, v56, s82
    v_perm_b32 v246, v68, v64, s82
    v_perm_b32 v247, v76, v72, s82
    v_mfma_f32_16x16x32_bf16 v[208:211], v[32:35], v[240:243], 0
    v_perm_b32 v240, v53, v49, s81
    v_perm_b32 v241, v61, v57, s81
    v_perm_b32 v242, v69, v65, s81
    v_perm_b32 v243, v77, v73, s81
    v_mfma_f32_16x16x32_bf16 v[212:215], v[32:35], v[244:247], 0
    v_perm_b32 v244, v53, v49, s82
    v_perm_b32 v245, v61, v57, s82
    v_perm_b32 v246, v69, v65, s82
    v_perm_b32 v247, v77, v73, s82
    v_mfma_f32_16x16x32_bf16 v[216:219], v[32:35], v[240:243], 0
    v_perm_b32 v240, v54, v50, s81
    v_perm_b32 v241, v62, v58, s81
    v_perm_b32 v242, v70, v66, s81
    v_perm_b32 v243, v78, v74, s81
    v_mfma_f32_16x16x32_bf16 v[220:223], v[32:35], v[244:247], 0
    v_perm_b32 v244, v54, v50, s82
    v_perm_b32 v245, v62, v58, s82
    v_perm_b32 v246, v70, v66, s82
    v_perm_b32 v247, v78, v74, s82
    v_mfma_f32_16x16x32_bf16 v[224:227], v[32:35], v[240:243], 0
    v_perm_b32 v240, v55, v51, s81
    v_perm_b32 v241, v63, v59, s81
    v_perm_b32 v242, v71, v67, s81
    v_perm_b32 v243, v79, v75, s81
    v_mfma_f32_16x16x32_bf16 v[228:231], v[32:35], v[244:247], 0
    v_perm_b32 v244, v55, v51, s82
    v_perm_b32 v245, v63, v59, s82
    v_perm_b32 v246, v71, v67, s82
    v_perm_b32 v247, v79, v75, s82
    v_mfma_f32_16x16x32_bf16 v[232:235], v[32:35], v[240:243], 0
    s_nop 1
    v_mfma_f32_16x16x32_bf16 v[236:239], v[32:35], v[244:247], 0
    s_waitcnt vmcnt(25)
    v_perm_b32 v240, v84, v80, s81
    v_perm_b32 v241, v92, v88, s81
    v_perm_b32 v242, v100, v96, s81
    v_perm_b32 v243, v108, v104, s81
    v_perm_b32 v244, v84, v80, s82
    v_perm_b32 v245, v92, v88, s82
    v_perm_b32 v246, v100, v96, s82
    v_perm_b32 v247, v108, v104, s82
    v_mfma_f32_16x16x32_bf16 v[208:211], v[36:39], v[240:243], v[208:211]
    v_perm_b32 v240, v85, v81, s81
    v_perm_b32 v241, v93, v89, s81
    v_perm_b32 v242, v101, v97, s81
    v_perm_b32 v243, v109, v105, s81
    v_mfma_f32_16x16x32_bf16 v[212:215], v[36:39], v[244:247], v[212:215]
    v_perm_b32 v244, v85, v81, s82
    v_perm_b32 v245, v93, v89, s82
    v_perm_b32 v246, v101, v97, s82
    v_perm_b32 v247, v109, v105, s82
    v_mfma_f32_16x16x32_bf16 v[216:219], v[36:39], v[240:243], v[216:219]
    v_perm_b32 v240, v86, v82, s81
    v_perm_b32 v241, v94, v90, s81
    v_perm_b32 v242, v102, v98, s81
    v_perm_b32 v243, v110, v106, s81
    v_mfma_f32_16x16x32_bf16 v[220:223], v[36:39], v[244:247], v[220:223]
    v_perm_b32 v244, v86, v82, s82
    v_perm_b32 v245, v94, v90, s82
    v_perm_b32 v246, v102, v98, s82
    v_perm_b32 v247, v110, v106, s82
    v_mfma_f32_16x16x32_bf16 v[224:227], v[36:39], v[240:243], v[224:227]
    v_perm_b32 v240, v87, v83, s81
    v_perm_b32 v241, v95, v91, s81
    v_perm_b32 v242, v103, v99, s81
    v_perm_b32 v243, v111, v107, s81
    v_mfma_f32_16x16x32_bf16 v[228:231], v[36:39], v[244:247], v[228:231]
    v_perm_b32 v244, v87, v83, s82
    v_perm_b32 v245, v95, v91, s82
    v_perm_b32 v246, v103, v99, s82
    v_perm_b32 v247, v111, v107, s82
    v_mfma_f32_16x16x32_bf16 v[232:235], v[36:39], v[240:243], v[232:235]
    s_nop 1
    v_mfma_f32_16x16x32_bf16 v[236:239], v[36:39], v[244:247], v[236:239]
    s_waitcnt vmcnt(17)
    v_perm_b32 v240, v116, v112, s81
    v_perm_b32 v241, v124, v120, s81
    v_perm_b32 v242, v132, v128, s81
    v_perm_b32 v243, v140, v136, s81
    v_perm_b32 v244, v116, v112, s82
    v_perm_b32 v245, v124, v120, s82
    v_perm_b32 v246, v132, v128, s82
    v_perm_b32 v247, v140, v136, s82
    v_mfma_f32_16x16x32_bf16 v[208:211], v[40:43], v[240:243], v[208:211]
    v_perm_b32 v240, v117, v113, s81
    v_perm_b32 v241, v125, v121, s81
    v_perm_b32 v242, v133, v129, s81
    v_perm_b32 v243, v141, v137, s81
    v_mfma_f32_16x16x32_bf16 v[212:215], v[40:43], v[244:247], v[212:215]
    v_perm_b32 v244, v117, v113, s82
    v_perm_b32 v245, v125, v121, s82
    v_perm_b32 v246, v133, v129, s82
    v_perm_b32 v247, v141, v137, s82
    v_mfma_f32_16x16x32_bf16 v[216:219], v[40:43], v[240:243], v[216:219]
    v_perm_b32 v240, v118, v114, s81
    v_perm_b32 v241, v126, v122, s81
    v_perm_b32 v242, v134, v130, s81
    v_perm_b32 v243, v142, v138, s81
    v_mfma_f32_16x16x32_bf16 v[220:223], v[40:43], v[244:247], v[220:223]
    v_perm_b32 v244, v118, v114, s82
    v_perm_b32 v245, v126, v122, s82
    v_perm_b32 v246, v134, v130, s82
    v_perm_b32 v247, v142, v138, s82
    v_mfma_f32_16x16x32_bf16 v[224:227], v[40:43], v[240:243], v[224:227]
    v_perm_b32 v240, v119, v115, s81
    v_perm_b32 v241, v127, v123, s81
    v_perm_b32 v242, v135, v131, s81
    v_perm_b32 v243, v143, v139, s81
    v_mfma_f32_16x16x32_bf16 v[228:231], v[40:43], v[244:247], v[228:231]
    v_perm_b32 v244, v119, v115, s82
    v_perm_b32 v245, v127, v123, s82
    v_perm_b32 v246, v135, v131, s82
    v_perm_b32 v247, v143, v139, s82
    v_mfma_f32_16x16x32_bf16 v[232:235], v[40:43], v[240:243], v[232:235]
    s_nop 1
    v_mfma_f32_16x16x32_bf16 v[236:239], v[40:43], v[244:247], v[236:239]
    s_waitcnt vmcnt(9)
    v_perm_b32 v240, v148, v144, s81
    v_perm_b32 v241, v156, v152, s81
    v_perm_b32 v242, v164, v160, s81
    v_perm_b32 v243, v172, v168, s81
    v_perm_b32 v244, v148, v144, s82
    v_perm_b32 v245, v156, v152, s82
    v_perm_b32 v246, v164, v160, s82
    v_perm_b32 v247, v172, v168, s82
    v_mfma_f32_16x16x32_bf16 v[208:211], v[44:47], v[240:243], v[208:211]
    v_perm_b32 v240, v149, v145, s81
    v_perm_b32 v241, v157, v153, s81
    v_perm_b32 v242, v165, v161, s81
    v_perm_b32 v243, v173, v169, s81
    v_mfma_f32_16x16x32_bf16 v[212:215], v[44:47], v[244:247], v[212:215]
    v_perm_b32 v244, v149, v145, s82
    v_perm_b32 v245, v157, v153, s82
    v_perm_b32 v246, v165, v161, s82
    v_perm_b32 v247, v173, v169, s82
    v_mfma_f32_16x16x32_bf16 v[216:219], v[44:47], v[240:243], v[216:219]
    v_perm_b32 v240, v150, v146, s81
    v_perm_b32 v241, v158, v154, s81
    v_perm_b32 v242, v166, v162, s81
    v_perm_b32 v243, v174, v170, s81
    v_mfma_f32_16x16x32_bf16 v[220:223], v[44:47], v[244:247], v[220:223]
    v_perm_b32 v244, v150, v146, s82
    v_perm_b32 v245, v158, v154, s82
    v_perm_b32 v246, v166, v162, s82
    v_perm_b32 v247, v174, v170, s82
    v_mfma_f32_16x16x32_bf16 v[224:227], v[44:47], v[240:243], v[224:227]
    v_perm_b32 v240, v151, v147, s81
    v_perm_b32 v241, v159, v155, s81
    v_perm_b32 v242, v167, v163, s81
    v_perm_b32 v243, v175, v171, s81
    v_mfma_f32_16x16x32_bf16 v[228:231], v[44:47], v[244:247], v[228:231]
    v_perm_b32 v244, v151, v147, s82
    v_perm_b32 v245, v159, v155, s82
    v_perm_b32 v246, v167, v163, s82
    v_perm_b32 v247, v175, v171, s82
    v_mfma_f32_16x16x32_bf16 v[232:235], v[44:47], v[240:243], v[232:235]
    s_nop 1
    v_mfma_f32_16x16x32_bf16 v[236:239], v[44:47], v[244:247], v[236:239]
    s_mul_i32 s77, s76, 1088
    s_add_u32 s77, s77, 131072
    v_lshlrev_b32 v15, 4, v2
    v_add_u32 v15, s77, v15
    v_mul_u32_u24 v16, 272, v2
    v_lshl_add_u32 v16, v3, 4, v16
    v_add_u32 v16, 131072, v16
    s_nop 3
    s_mov_b64 exec, 0xffff
    v_cvt_pk_bf16_f32 v48, v208, v212
    v_cvt_pk_bf16_f32 v49, v216, v220
    v_cvt_pk_bf16_f32 v50, v224, v228
    v_cvt_pk_bf16_f32 v51, v232, v236
    ds_write_b128 v15, v[48:51] offset:0
    v_cvt_pk_bf16_f32 v52, v209, v213
    v_cvt_pk_bf16_f32 v53, v217, v221
    v_cvt_pk_bf16_f32 v54, v225, v229
    v_cvt_pk_bf16_f32 v55, v233, v237
    ds_write_b128 v15, v[52:55] offset:272
    v_cvt_pk_bf16_f32 v56, v210, v214
    v_cvt_pk_bf16_f32 v57, v218, v222
    v_cvt_pk_bf16_f32 v58, v226, v230
    v_cvt_pk_bf16_f32 v59, v234, v238
    ds_write_b128 v15, v[56:59] offset:544
    v_cvt_pk_bf16_f32 v60, v211, v215
    v_cvt_pk_bf16_f32 v61, v219, v223
    v_cvt_pk_bf16_f32 v62, v227, v231
    v_cvt_pk_bf16_f32 v63, v235, v239
    ds_write_b128 v15, v[60:63] offset:816
    s_mov_b64 exec, -1
    s_waitcnt lgkmcnt(0)
    v_mov_b32 v6, 1
    ds_write_b32 v4, v6
L_sw_2:
    ds_read_b128 v[252:255], v5 offset:0
    s_waitcnt lgkmcnt(0)
    v_min_u32 v252, v252, v253
    v_min3_u32 v252, v252, v254, v255
    s_sub_u32 s84, s84, 1
    s_cbranch_scc1 L_end
    v_readfirstlane_b32 s80, v252
    s_cmp_ge_u32 s80, 1
    s_cbranch_scc0 L_sw_2
    ds_read_b128 v[32:35], v16 offset:0
    ds_read_b128 v[36:39], v16 offset:64
    ds_read_b128 v[40:43], v16 offset:128
    ds_read_b128 v[44:47], v16 offset:192
    s_waitcnt vmcnt(1)
    s_waitcnt lgkmcnt(0)
    v_mfma_f32_16x16x32_bf16 v[208:211], v[176:179], v[32:35], 0
    v_mfma_f32_16x16x32_bf16 v[212:215], v[192:195], v[32:35], 0
    v_mfma_f32_16x16x32_bf16 v[208:211], v[180:183], v[36:39], v[208:211]
    v_mfma_f32_16x16x32_bf16 v[212:215], v[196:199], v[36:39], v[212:215]
    v_mfma_f32_16x16x32_bf16 v[208:211], v[184:187], v[40:43], v[208:211]
    v_mfma_f32_16x16x32_bf16 v[212:215], v[200:203], v[40:43], v[212:215]
    v_mfma_f32_16x16x32_bf16 v[208:211], v[188:191], v[44:47], v[208:211]
    v_mfma_f32_16x16x32_bf16 v[212:215], v[204:207], v[44:47], v[212:215]
    v_lshlrev_b32 v17, 15, v2
    v_lshrrev_b32 v6, 1, v3
    v_lshl_add_u32 v17, v6, 9, v17
    v_and_b32 v6, 1, v3
    v_lshl_add_u32 v17, v6, 3, v17
    s_lshl_b32 s77, s73, 17
    s_lshl_b32 s78, s74, 13
    s_add_u32 s77, s77, s78
    s_lshl_b32 s78, s76, 11
    s_add_u32 s77, s77, s78
    s_lshl_b32 s78, s72, 4
    s_add_u32 s77, s77, s78
    s_nop 3
    v_add_f32_dpp v208, v208, v208 row_ror:8 row_mask:0xf bank_mask:0xf
    v_add_f32_dpp v209, v209, v209 row_ror:8 row_mask:0xf bank_mask:0xf
    v_add_f32_dpp v210, v210, v210 row_ror:8 row_mask:0xf bank_mask:0xf
    v_add_f32_dpp v211, v211, v211 row_ror:8 row_mask:0xf bank_mask:0xf
    v_add_f32_dpp v212, v212, v212 row_ror:8 row_mask:0xf bank_mask:0xf
    v_add_f32_dpp v213, v213, v213 row_ror:8 row_mask:0xf bank_mask:0xf
    v_add_f32_dpp v214, v214, v214 row_ror:8 row_mask:0xf bank_mask:0xf
    v_add_f32_dpp v215, v215, v215 row_ror:8 row_mask:0xf bank_mask:0xf
    v_add_f32_dpp v208, v208, v208 row_ror:4 row_mask:0xf bank_mask:0xf
    v_add_f32_dpp v209, v209, v209 row_ror:4 row_mask:0xf bank_mask:0xf
    v_add_f32_dpp v210, v210, v210 row_ror:4 row_mask:0xf bank_mask:0xf
    v_add_f32_dpp v211, v211, v211 row_ror:4 row_mask:0xf bank_mask:0xf
    v_add_f32_dpp v212, v212, v212 row_ror:4 row_mask:0xf bank_mask:0xf
    v_add_f32_dpp v213, v213, v213 row_ror:4 row_mask:0xf bank_mask:0xf
    v_add_f32_dpp v214, v214, v214 row_ror:4 row_mask:0xf bank_mask:0xf
    v_add_f32_dpp v215, v215, v215 row_ror:4 row_mask:0xf bank_mask:0xf
    v_mul_f32 v208, s83, v208
    v_mul_f32 v209, s83, v209
    v_mul_f32 v210, s83, v210
    v_mul_f32 v211, s83, v211
    v_mul_f32 v212, s83, v212
    v_mul_f32 v213, s83, v213
    v_mul_f32 v214, s83, v214
    v_mul_f32 v215, s83, v215
    v_cvt_pk_bf16_f32 v48, v208, v209
    v_cvt_pk_bf16_f32 v49, v210, v211
    v_cvt_pk_bf16_f32 v50, v212, v213
    v_cvt_pk_bf16_f32 v51, v214, v215
    s_mov_b32 exec_lo, 0x000f000f
    s_mov_b32 exec_hi, 0x000f000f
    buffer_store_dwordx2 v[48:49], v17, s[68:71], s77 offen offset:0 sc1
    buffer_store_dwordx2 v[50:51], v17, s[68:71], s77 offen offset:1024 sc1
    s_mov_b64 exec, -1
    v_mov_b32 v6, 2
    ds_write_b32 v4, v6
L_non_3:
    s_waitcnt vmcnt(0)
    v_readfirstlane_b32 s85, v30
    s_cmp_lg_u32 s85, 0
    s_cbranch_scc1 L_nond_4
    s_sub_u32 s84, s84, 1
    s_cbranch_scc1 L_end
    s_sleep 4
    buffer_load_dword v30, v12, s[64:67], 0 offen sc1
    s_branch L_non_3
L_nond_4:
L_sw_5:
    ds_read_b32 v252, v5 offset:36
    s_waitcnt lgkmcnt(0)
    s_sub_u32 s84, s84, 1
    s_cbranch_scc1 L_end
    v_readfirstlane_b32 s80, v252
    s_cmp_ge_u32 s80, 1
    s_cbranch_scc0 L_sw_5
    s_lshl_b32 s77, s73, 2
    s_add_u32 s77, s77, s74
    s_lshl_b32 s77, s77, 2
    s_add_u32 s77, s77, s76
    s_lshl_b32 s77, s77, 5
    s_add_u32 s77, s77, s72
    s_lshl_b32 s77, s77, 2
    s_add_u32 s77, s77, 458752
    s_mov_b64 exec, 1
    buffer_store_dword v30, v12, s[68:71], s77 offen sc1
    s_mov_b64 exec, -1
    s_lshl_b32 s77, s96, 2
    s_add_u32 s77, s77, s97
    s_lshl_b32 s86, s77, 15
    s_lshl_b32 s78, s76, 13
    s_add_u32 s87, s86, s78
    s_add_u32 s87, s87, 2048
    s_add_u32 s88, s87, 4096
    s_lshl_b32 s89, s96, 11
    s_add_u32 s89, s89, 458752
    s_add_u32 s78, s78, 131072
    v_add_u32 v15, s78, v13
    v_add_u32 v16, 131072, v13
    v_and_b32 v17, 31, v1
    v_lshrrev_b32 v18, 5, v1
    v_and_b32 v19, 3, v17
    v_bfe_u32 v6, v17, 2, 2
    v_lshl_add_u32 v19, v19, 2, v6
    v_xor_b32 v19, v19, v18
    s_lshl_b32 s78, s76, 15
    v_lshlrev_b32 v6, 10, v17
    v_add_u32 v6, s78, v6
    v_xor_b32 v7, 0, v19
    v_lshl_add_u32 v80, v7, 4, v6
    v_xor_b32 v7, 2, v19
    v_lshl_add_u32 v81, v7, 4, v6
    v_xor_b32 v7, 4, v19
    v_lshl_add_u32 v82, v7, 4, v6
    v_xor_b32 v7, 6, v19
    v_lshl_add_u32 v83, v7, 4, v6
    v_xor_b32 v7, 8, v19
    v_lshl_add_u32 v84, v7, 4, v6
    v_xor_b32 v7, 10, v19
    v_lshl_add_u32 v85, v7, 4, v6
    v_xor_b32 v7, 12, v19
    v_lshl_add_u32 v86, v7, 4, v6
    v_xor_b32 v7, 14, v19
    v_lshl_add_u32 v87, v7, 4, v6
    v_lshlrev_b32 v23, 4, v17
    v_add_u32 v23, 162048, v23
    s_lshl_b32 s77, s76, 2
    v_add_u32 v26, s77, v23
    v_mul_u32_u24 v25, 272, v17
    v_add_u32 v25, 131072, v25
    s_lshl_b32 s77, s76, 6
    v_lshl_add_u32 v24, v18, 3, v25
    v_add_u32 v24, s77, v24
    v_lshl_add_u32 v25, v18, 4, v25
    v_bfe_u32 v241, v1, 4, 1
    v_lshrrev_b32 v240, 2, v2
    v_lshl_add_u32 v6, v18, 3, v240
    v_lshlrev_b32 v6, 10, v6
    v_and_b32 v7, 1, v2
    v_lshl_add_u32 v6, v7, 3, v6
    s_lshl_b32 s77, s76, 8
    v_add_u32 v6, s77, v6
    v_bfe_u32 v7, v2, 1, 1
    v_lshl_add_u32 v7, v241, 1, v7
    v_lshlrev_b32 v242, 1, v18
    v_xor_b32 v7, v7, v242
    v_xor_b32 v242, 0, v240
    v_lshl_add_u32 v242, v242, 2, v7
    v_lshl_add_u32 v88, v242, 4, v6
    v_xor_b32 v242, 0, v240
    v_lshl_add_u32 v242, v242, 2, v7
    v_xor_b32 v242, 1, v242
    v_lshl_add_u32 v89, v242, 4, v6
    v_add_u32 v89, 4096, v89
    v_xor_b32 v242, 1, v240
    v_lshl_add_u32 v242, v242, 2, v7
    v_lshl_add_u32 v90, v242, 4, v6
    v_xor_b32 v242, 1, v240
    v_lshl_add_u32 v242, v242, 2, v7
    v_xor_b32 v242, 1, v242
    v_lshl_add_u32 v91, v242, 4, v6
    v_add_u32 v91, 4096, v91
    v_xor_b32 v242, 2, v240
    v_lshl_add_u32 v242, v242, 2, v7
    v_lshl_add_u32 v92, v242, 4, v6
    v_xor_b32 v242, 2, v240
    v_lshl_add_u32 v242, v242, 2, v7
    v_xor_b32 v242, 1, v242
    v_lshl_add_u32 v93, v242, 4, v6
    v_add_u32 v93, 4096, v93
    v_xor_b32 v242, 3, v240
    v_lshl_add_u32 v242, v242, 2, v7
    v_lshl_add_u32 v94, v242, 4, v6
    v_xor_b32 v242, 3, v240
    v_lshl_add_u32 v242, v242, 2, v7
    v_xor_b32 v242, 1, v242
    v_lshl_add_u32 v95, v242, 4, v6
    v_add_u32 v95, 4096, v95
    s_mul_i32 s77, s76, 4608
    s_add_u32 s77, s77, 139776
    v_mul_u32_u24 v27, 144, v17
    v_lshl_add_u32 v27, v18, 3, v27
    v_add_u32 v27, s77, v27
    v_lshrrev_b32 v6, 3, v1
    v_and_b32 v7, 7, v1
    v_mul_u32_u24 v28, 144, v6
    v_lshl_add_u32 v28, v7, 4, v28
    v_add_u32 v28, s77, v28
    v_lshlrev_b32 v29, 17, v6
    v_lshl_add_u32 v29, v7, 4, v29
    s_lshl_b32 s77, s96, 22
    s_lshl_b32 s78, s76, 15
    s_add_u32 s77, s77, s78
    s_lshl_b32 s78, s97, 13
    s_add_u32 s77, s77, s78
    s_lshl_b32 s78, s98, 8
    s_add_u32 s77, s77, s78
    s_add_u32 s32, s77, 1048576
    s_add_u32 s33, s32, 1048576
    s_add_u32 s34, s32, 2097152
    s_add_u32 s35, s32, 3145728
L_sw_6:
    ds_read_b128 v[252:255], v5 offset:0
    s_waitcnt lgkmcnt(0)
    v_min_u32 v252, v252, v253
    v_min3_u32 v252, v252, v254, v255
    s_sub_u32 s84, s84, 1
    s_cbranch_scc1 L_end
    v_readfirstlane_b32 s80, v252
    s_cmp_ge_u32 s80, 2
    s_cbranch_scc0 L_sw_6
L_sw_7:
    ds_read_b32 v252, v14
    s_waitcnt lgkmcnt(0)
    s_sub_u32 s84, s84, 1
    s_cbranch_scc1 L_end
    v_readfirstlane_b32 s80, v252
    s_cmp_ge_u32 s80, 1
    s_cbranch_scc0 L_sw_7
    s_cmp_lg_u32 s76, 0
    s_cbranch_scc1 L_notw0_8
L_q_10:
    buffer_load_dwordx4 v[96:99], v13, s[68:71], s89 offen offset:0 sc1
    buffer_load_dwordx4 v[100:103], v13, s[68:71], s89 offen offset:1024 sc1
    s_waitcnt vmcnt(0)
    v_xor_b32 v96, s85, v96
    v_xor_b32 v97, s85, v97
    v_xor_b32 v98, s85, v98
    v_xor_b32 v99, s85, v99
    v_xor_b32 v100, s85, v100
    v_xor_b32 v101, s85, v101
    v_xor_b32 v102, s85, v102
    v_xor_b32 v103, s85, v103
    v_or3_b32 v6, v96, v97, v98
    v_or3_b32 v6, v6, v99, v100
    v_or3_b32 v6, v6, v101, v102
    v_or_b32 v6, v6, v103
    v_cmp_ne_u32 vcc, 0, v6
    s_cbranch_vccz L_qd_11
    s_sub_u32 s84, s84, 1
    s_cbranch_scc1 L_end
    s_sleep 4
    s_branch L_q_10
L_qd_11:
    v_mov_b32 v6, 1
    ds_write_b32 v5, v6 offset:32
    s_branch L_join_9
L_notw0_8:
L_sw_12:
    ds_read_b32 v252, v5 offset:32
    s_waitcnt lgkmcnt(0)
    s_sub_u32 s84, s84, 1
    s_cbranch_scc1 L_end
    v_readfirstlane_b32 s80, v252
    s_cmp_ge_u32 s80, 1
    s_cbranch_scc0 L_sw_12
L_join_9:
    buffer_load_dwordx4 v[32:35], v13, s[68:71], s86 offen offset:0
    buffer_load_dwordx4 v[36:39], v13, s[68:71], s86 offen offset:1024
    buffer_load_dwordx4 v[96:99], v13, s[68:71], s87 offen offset:0
    buffer_load_dwordx4 v[100:103], v13, s[68:71], s87 offen offset:1024
    buffer_load_dwordx4 v[104:107], v13, s[68:71], s87 offen offset:2048
    buffer_load_dwordx4 v[108:111], v13, s[68:71], s87 offen offset:3072
    buffer_load_dwordx4 v[112:115], v13, s[68:71], s88 offen offset:0
    buffer_load_dwordx4 v[116:119], v13, s[68:71], s88 offen offset:1024
    s_cmp_eq_u32 s76, 3
    s_cbranch_scc1 L_w3_13
    buffer_load_dwordx4 v[120:123], v13, s[68:71], s88 offen offset:2048
    buffer_load_dwordx4 v[124:127], v13, s[68:71], s88 offen offset:3072
    s_waitcnt vmcnt(0)
    ds_write_b128 v15, v[120:123] offset:6144
    ds_write_b128 v15, v[124:127] offset:7168
L_w3_13:
    s_waitcnt vmcnt(0)
    ds_write_b128 v15, v[96:99] offset:0
    ds_write_b128 v15, v[100:103] offset:1024
    ds_write_b128 v15, v[104:107] offset:2048
    ds_write_b128 v15, v[108:111] offset:3072
    ds_write_b128 v15, v[112:115] offset:4096
    ds_write_b128 v15, v[116:119] offset:5120
    s_waitcnt lgkmcnt(0)
    v_mov_b32 v6, 3
    ds_write_b32 v4, v6
L_sw_14:
    ds_read_b128 v[252:255], v5 offset:0
    s_waitcnt lgkmcnt(0)
    v_min_u32 v252, v252, v253
    v_min3_u32 v252, v252, v254, v255
    s_sub_u32 s84, s84, 1
    s_cbranch_scc1 L_end
    v_readfirstlane_b32 s80, v252
    s_cmp_ge_u32 s80, 3
    s_cbranch_scc0 L_sw_14
L_sw_15:
    ds_read_b32 v252, v14
    s_waitcnt lgkmcnt(0)
    s_sub_u32 s84, s84, 1
    s_cbranch_scc1 L_end
    v_readfirstlane_b32 s80, v252
    s_cmp_ge_u32 s80, 2
    s_cbranch_scc0 L_sw_15
    ds_read_b128 v[48:51], v80 offset:0
    ds_read_b128 v[52:55], v81 offset:0
    ds_read_b128 v[56:59], v82 offset:0
    ds_read_b128 v[72:75], v16 offset:0
    ds_read_b128 v[60:63], v83 offset:0
    ds_read_b128 v[76:79], v16 offset:1024
    s_waitcnt lgkmcnt(5)
    v_mfma_f32_32x32x16_bf16 v[208:223], v[48:51], v[32:35], 0
    ds_read_b128 v[48:51], v84 offset:0
    ds_read_b128 v[64:67], v16 offset:2048
    s_waitcnt lgkmcnt(6)
    v_mfma_f32_32x32x16_bf16 v[208:223], v[52:55], v[36:39], v[208:223]
    ds_read_b128 v[52:55], v85 offset:0
    ds_read_b128 v[68:71], v16 offset:3072
    s_waitcnt lgkmcnt(6)
    v_mfma_f32_32x32x16_bf16 v[208:223], v[56:59], v[72:75], v[208:223]
    ds_read_b128 v[56:59], v86 offset:0
    ds_read_b128 v[72:75], v16 offset:4096
    s_waitcnt lgkmcnt(6)
    v_mfma_f32_32x32x16_bf16 v[208:223], v[60:63], v[76:79], v[208:223]
    ds_read_b128 v[60:63], v87 offset:0
    ds_read_b128 v[76:79], v16 offset:5120
    s_waitcnt lgkmcnt(6)
    v_mfma_f32_32x32x16_bf16 v[208:223], v[48:51], v[64:67], v[208:223]
    ds_read_b128 v[48:51], v80 offset:256
    ds_read_b128 v[64:67], v16 offset:6144
    s_waitcnt lgkmcnt(6)
    v_mfma_f32_32x32x16_bf16 v[208:223], v[52:55], v[68:71], v[208:223]
    ds_read_b128 v[52:55], v81 offset:256
    ds_read_b128 v[68:71], v16 offset:7168
    s_waitcnt lgkmcnt(6)
    v_mfma_f32_32x32x16_bf16 v[208:223], v[56:59], v[72:75], v[208:223]
    ds_read_b128 v[56:59], v82 offset:256
    ds_read_b128 v[72:75], v16 offset:8192
    s_waitcnt lgkmcnt(6)
    v_mfma_f32_32x32x16_bf16 v[208:223], v[60:63], v[76:79], v[208:223]
    ds_read_b128 v[60:63], v83 offset:256
    ds_read_b128 v[76:79], v16 offset:9216
    s_waitcnt lgkmcnt(6)
    v_mfma_f32_32x32x16_bf16 v[208:223], v[48:51], v[64:67], v[208:223]
    ds_read_b128 v[48:51], v84 offset:256
    ds_read_b128 v[64:67], v16 offset:10240
    s_waitcnt lgkmcnt(6)
    v_mfma_f32_32x32x16_bf16 v[208:223], v[52:55], v[68:71], v[208:223]
    ds_read_b128 v[52:55], v85 offset:256
    ds_read_b128 v[68:71], v16 offset:11264
    s_waitcnt lgkmcnt(6)
    v_mfma_f32_32x32x16_bf16 v[208:223], v[56:59], v[72:75], v[208:223]
    ds_read_b128 v[56:59], v86 offset:256
    ds_read_b128 v[72:75], v16 offset:12288
    s_waitcnt lgkmcnt(6)
    v_mfma_f32_32x32x16_bf16 v[208:223], v[60:63], v[76:79], v[208:223]
    ds_read_b128 v[60:63], v87 offset:256
    ds_read_b128 v[76:79], v16 offset:13312
    s_waitcnt lgkmcnt(6)
    v_mfma_f32_32x32x16_bf16 v[208:223], v[48:51], v[64:67], v[208:223]
    ds_read_b128 v[48:51], v80 offset:512
    ds_read_b128 v[64:67], v16 offset:14336
    s_waitcnt lgkmcnt(6)
    v_mfma_f32_32x32x16_bf16 v[208:223], v[52:55], v[68:71], v[208:223]
    ds_read_b128 v[52:55], v81 offset:512
    ds_read_b128 v[68:71], v16 offset:15360
    s_waitcnt lgkmcnt(6)
    v_mfma_f32_32x32x16_bf16 v[208:223], v[56:59], v[72:75], v[208:223]
    ds_read_b128 v[56:59], v82 offset:512
    ds_read_b128 v[72:75], v16 offset:16384
    s_waitcnt lgkmcnt(6)
    v_mfma_f32_32x32x16_bf16 v[208:223], v[60:63], v[76:79], v[208:223]
    ds_read_b128 v[60:63], v83 offset:512
    ds_read_b128 v[76:79], v16 offset:17408
    s_waitcnt lgkmcnt(6)
    v_mfma_f32_32x32x16_bf16 v[208:223], v[48:51], v[64:67], v[208:223]
    ds_read_b128 v[48:51], v84 offset:512
    ds_read_b128 v[64:67], v16 offset:18432
    s_waitcnt lgkmcnt(6)
    v_mfma_f32_32x32x16_bf16 v[208:223], v[52:55], v[68:71], v[208:223]
    ds_read_b128 v[52:55], v85 offset:512
    ds_read_b128 v[68:71], v16 offset:19456
    s_waitcnt lgkmcnt(6)
    v_mfma_f32_32x32x16_bf16 v[208:223], v[56:59], v[72:75], v[208:223]
    ds_read_b128 v[56:59], v86 offset:512
    ds_read_b128 v[72:75], v16 offset:20480
    s_waitcnt lgkmcnt(6)
    v_mfma_f32_32x32x16_bf16 v[208:223], v[60:63], v[76:79], v[208:223]
    ds_read_b128 v[60:63], v87 offset:512
    ds_read_b128 v[76:79], v16 offset:21504
    s_waitcnt lgkmcnt(6)
    v_mfma_f32_32x32x16_bf16 v[208:223], v[48:51], v[64:67], v[208:223]
    ds_read_b128 v[48:51], v80 offset:768
    ds_read_b128 v[64:67], v16 offset:22528
    s_waitcnt lgkmcnt(6)
    v_mfma_f32_32x32x16_bf16 v[208:223], v[52:55], v[68:71], v[208:223]
    ds_read_b128 v[52:55], v81 offset:768
    ds_read_b128 v[68:71], v16 offset:23552
    s_waitcnt lgkmcnt(6)
    v_mfma_f32_32x32x16_bf16 v[208:223], v[56:59], v[72:75], v[208:223]
    ds_read_b128 v[56:59], v82 offset:768
    ds_read_b128 v[72:75], v16 offset:24576
    s_waitcnt lgkmcnt(6)
    v_mfma_f32_32x32x16_bf16 v[208:223], v[60:63], v[76:79], v[208:223]
    ds_read_b128 v[60:63], v83 offset:768
    ds_read_b128 v[76:79], v16 offset:25600
    s_waitcnt lgkmcnt(6)
    v_mfma_f32_32x32x16_bf16 v[208:223], v[48:51], v[64:67], v[208:223]
    ds_read_b128 v[48:51], v84 offset:768
    ds_read_b128 v[64:67], v16 offset:26624
    s_waitcnt lgkmcnt(6)
    v_mfma_f32_32x32x16_bf16 v[208:223], v[52:55], v[68:71], v[208:223]
    ds_read_b128 v[52:55], v85 offset:768
    ds_read_b128 v[68:71], v16 offset:27648
    s_waitcnt lgkmcnt(6)
    v_mfma_f32_32x32x16_bf16 v[208:223], v[56:59], v[72:75], v[208:223]
    ds_read_b128 v[56:59], v86 offset:768
    ds_read_b128 v[72:75], v16 offset:28672
    s_waitcnt lgkmcnt(6)
    v_mfma_f32_32x32x16_bf16 v[208:223], v[60:63], v[76:79], v[208:223]
    ds_read_b128 v[60:63], v87 offset:768
    ds_read_b128 v[76:79], v16 offset:29696
    s_waitcnt lgkmcnt(6)
    v_mfma_f32_32x32x16_bf16 v[208:223], v[48:51], v[64:67], v[208:223]
    s_waitcnt lgkmcnt(4)
    v_mfma_f32_32x32x16_bf16 v[208:223], v[52:55], v[68:71], v[208:223]
    s_waitcnt lgkmcnt(2)
    v_mfma_f32_32x32x16_bf16 v[208:223], v[56:59], v[72:75], v[208:223]
    s_waitcnt lgkmcnt(0)
    v_mfma_f32_32x32x16_bf16 v[208:223], v[60:63], v[76:79], v[208:223]
    s_nop 15
    v_max3_f32 v20, v208, v209, v210
    v_max3_f32 v20, v20, v211, v212
    v_max3_f32 v20, v20, v213, v214
    v_max3_f32 v20, v20, v215, v216
    v_max3_f32 v20, v20, v217, v218
    v_max3_f32 v20, v20, v219, v220
    v_max3_f32 v20, v20, v221, v222
    v_max_f32 v20, v20, v223
    v_mov_b32 v21, v20
    s_nop 1
    v_permlane32_swap_b32 v20, v21
    v_max_f32 v20, v20, v21
    ds_write_b32 v26, v20
    s_waitcnt lgkmcnt(0)
    v_mov_b32 v6, 4
    ds_write_b32 v4, v6
L_sw_16:
    ds_read_b128 v[252:255], v5 offset:0
    s_waitcnt lgkmcnt(0)
    v_min_u32 v252, v252, v253
    v_min3_u32 v252, v252, v254, v255
    s_sub_u32 s84, s84, 1
    s_cbranch_scc1 L_end
    v_readfirstlane_b32 s80, v252
    s_cmp_ge_u32 s80, 4
    s_cbranch_scc0 L_sw_16
    ds_read_b128 v[48:51], v23
    s_waitcnt lgkmcnt(0)
    v_max3_f32 v20, v48, v49, v50
    v_max_f32 v20, v20, v51
    v_sub_f32 v208, v208, v20
    v_sub_f32 v209, v209, v20
    v_sub_f32 v210, v210, v20
    v_sub_f32 v211, v211, v20
    v_sub_f32 v212, v212, v20
    v_sub_f32 v213, v213, v20
    v_sub_f32 v214, v214, v20
    v_sub_f32 v215, v215, v20
    v_sub_f32 v216, v216, v20
    v_sub_f32 v217, v217, v20
    v_sub_f32 v218, v218, v20
    v_sub_f32 v219, v219, v20
    v_sub_f32 v220, v220, v20
    v_sub_f32 v221, v221, v20
    v_sub_f32 v222, v222, v20
    v_sub_f32 v223, v223, v20
    v_exp_f32 v208, v208
    v_exp_f32 v209, v209
    v_exp_f32 v210, v210
    v_exp_f32 v211, v211
    v_exp_f32 v212, v212
    v_exp_f32 v213, v213
    v_exp_f32 v214, v214
    v_exp_f32 v215, v215
    v_exp_f32 v216, v216
    v_exp_f32 v217, v217
    v_exp_f32 v218, v218
    v_exp_f32 v219, v219
    v_exp_f32 v220, v220
    v_exp_f32 v221, v221
    v_exp_f32 v222, v222
    v_exp_f32 v223, v223
    s_nop 0
    v_cvt_pk_bf16_f32 v48, v208, v209
    v_cvt_pk_bf16_f32 v49, v210, v211
    ds_write_b64 v24, v[48:49] offset:0
    v_cvt_pk_bf16_f32 v50, v212, v213
    v_cvt_pk_bf16_f32 v51, v214, v215
    ds_write_b64 v24, v[50:51] offset:16
    v_cvt_pk_bf16_f32 v52, v216, v217
    v_cvt_pk_bf16_f32 v53, v218, v219
    ds_write_b64 v24, v[52:53] offset:32
    v_cvt_pk_bf16_f32 v54, v220, v221
    v_cvt_pk_bf16_f32 v55, v222, v223
    ds_write_b64 v24, v[54:55] offset:48
    v_add_f32 v22, v208, v209
    v_add_f32 v22, v22, v210
    v_add_f32 v22, v22, v211
    v_add_f32 v22, v22, v212
    v_add_f32 v22, v22, v213
    v_add_f32 v22, v22, v214
    v_add_f32 v22, v22, v215
    v_add_f32 v22, v22, v216
    v_add_f32 v22, v22, v217
    v_add_f32 v22, v22, v218
    v_add_f32 v22, v22, v219
    v_add_f32 v22, v22, v220
    v_add_f32 v22, v22, v221
    v_add_f32 v22, v22, v222
    v_add_f32 v22, v22, v223
    v_mov_b32 v21, v22
    s_nop 1
    v_permlane32_swap_b32 v22, v21
    v_add_f32 v22, v22, v21
    ds_write_b32 v26, v22 offset:512
    s_waitcnt lgkmcnt(0)
    v_mov_b32 v6, 5
    ds_write_b32 v4, v6
L_sw_17:
    ds_read_b128 v[252:255], v5 offset:0
    s_waitcnt lgkmcnt(0)
    v_min_u32 v252, v252, v253
    v_min3_u32 v252, v252, v254, v255
    s_sub_u32 s84, s84, 1
    s_cbranch_scc1 L_end
    v_readfirstlane_b32 s80, v252
    s_cmp_ge_u32 s80, 5
    s_cbranch_scc0 L_sw_17
    ds_read_b128 v[56:59], v23 offset:512
    ds_read_b128 v[32:35], v25 offset:0
    ds_read_b64_tr_b16 v[208:209], v88 offset:0
    ds_read_b64_tr_b16 v[210:211], v89 offset:0
    ds_read_b64_tr_b16 v[212:213], v90 offset:0
    ds_read_b64_tr_b16 v[214:215], v91 offset:0
    ds_read_b128 v[36:39], v25 offset:32
    ds_read_b64_tr_b16 v[216:217], v88 offset:16384
    ds_read_b64_tr_b16 v[218:219], v89 offset:16384
    ds_read_b64_tr_b16 v[220:221], v90 offset:16384
    ds_read_b64_tr_b16 v[222:223], v91 offset:16384
    ds_read_b128 v[40:43], v25 offset:64
    ds_read_b64_tr_b16 v[224:225], v88 offset:32768
    ds_read_b64_tr_b16 v[226:227], v89 offset:32768
    ds_read_b64_tr_b16 v[228:229], v90 offset:32768
    ds_read_b64_tr_b16 v[230:231], v91 offset:32768
    s_waitcnt lgkmcnt(12)
    v_mfma_f32_32x32x16_bf16 v[96:111], v[208:211], v[32:35], 0
    s_waitcnt lgkmcnt(10)
    v_mfma_f32_32x32x16_bf16 v[112:127], v[212:215], v[32:35], 0
    ds_read_b128 v[32:35], v25 offset:96
    ds_read_b64_tr_b16 v[208:209], v88 offset:49152
    ds_read_b64_tr_b16 v[210:211], v89 offset:49152
    ds_read_b64_tr_b16 v[212:213], v90 offset:49152
    ds_read_b64_tr_b16 v[214:215], v91 offset:49152
    s_waitcnt lgkmcnt(12)
    v_mfma_f32_32x32x16_bf16 v[96:111], v[216:219], v[36:39], v[96:111]
    s_waitcnt lgkmcnt(10)
    v_mfma_f32_32x32x16_bf16 v[112:127], v[220:223], v[36:39], v[112:127]
    v_add_u32 v88, 0x10000, v88
    v_add_u32 v89, 0x10000, v89
    v_add_u32 v90, 0x10000, v90
    v_add_u32 v91, 0x10000, v91
    ds_read_b128 v[36:39], v25 offset:128
    ds_read_b64_tr_b16 v[216:217], v88 offset:0
    ds_read_b64_tr_b16 v[218:219], v89 offset:0
    ds_read_b64_tr_b16 v[220:221], v90 offset:0
    ds_read_b64_tr_b16 v[222:223], v91 offset:0
    s_waitcnt lgkmcnt(12)
    v_mfma_f32_32x32x16_bf16 v[96:111], v[224:227], v[40:43], v[96:111]
    s_waitcnt lgkmcnt(10)
    v_mfma_f32_32x32x16_bf16 v[112:127], v[228:231], v[40:43], v[112:127]
    ds_read_b128 v[40:43], v25 offset:160
    ds_read_b64_tr_b16 v[224:225], v88 offset:16384
    ds_read_b64_tr_b16 v[226:227], v89 offset:16384
    ds_read_b64_tr_b16 v[228:229], v90 offset:16384
    ds_read_b64_tr_b16 v[230:231], v91 offset:16384
    s_waitcnt lgkmcnt(12)
    v_mfma_f32_32x32x16_bf16 v[96:111], v[208:211], v[32:35], v[96:111]
    s_waitcnt lgkmcnt(10)
    v_mfma_f32_32x32x16_bf16 v[112:127], v[212:215], v[32:35], v[112:127]
    ds_read_b128 v[32:35], v25 offset:192
    ds_read_b64_tr_b16 v[208:209], v88 offset:32768
    ds_read_b64_tr_b16 v[210:211], v89 offset:32768
    ds_read_b64_tr_b16 v[212:213], v90 offset:32768
    ds_read_b64_tr_b16 v[214:215], v91 offset:32768
    s_waitcnt lgkmcnt(12)
    v_mfma_f32_32x32x16_bf16 v[96:111], v[216:219], v[36:39], v[96:111]
    s_waitcnt lgkmcnt(10)
    v_mfma_f32_32x32x16_bf16 v[112:127], v[220:223], v[36:39], v[112:127]
    ds_read_b128 v[36:39], v25 offset:224
    ds_read_b64_tr_b16 v[216:217], v88 offset:49152
    ds_read_b64_tr_b16 v[218:219], v89 offset:49152
    ds_read_b64_tr_b16 v[220:221], v90 offset:49152
    ds_read_b64_tr_b16 v[222:223], v91 offset:49152
    s_waitcnt lgkmcnt(12)
    v_mfma_f32_32x32x16_bf16 v[96:111], v[224:227], v[40:43], v[96:111]
    s_waitcnt lgkmcnt(10)
    v_mfma_f32_32x32x16_bf16 v[112:127], v[228:231], v[40:43], v[112:127]
    ds_read_b128 v[40:43], v25 offset:0
    ds_read_b64_tr_b16 v[224:225], v92 offset:0
    ds_read_b64_tr_b16 v[226:227], v93 offset:0
    ds_read_b64_tr_b16 v[228:229], v94 offset:0
    ds_read_b64_tr_b16 v[230:231], v95 offset:0
    s_waitcnt lgkmcnt(12)
    v_mfma_f32_32x32x16_bf16 v[96:111], v[208:211], v[32:35], v[96:111]
    s_waitcnt lgkmcnt(10)
    v_mfma_f32_32x32x16_bf16 v[112:127], v[212:215], v[32:35], v[112:127]
    ds_read_b128 v[32:35], v25 offset:32
    ds_read_b64_tr_b16 v[208:209], v92 offset:16384
    ds_read_b64_tr_b16 v[210:211], v93 offset:16384
    ds_read_b64_tr_b16 v[212:213], v94 offset:16384
    ds_read_b64_tr_b16 v[214:215], v95 offset:16384
    s_waitcnt lgkmcnt(12)
    v_mfma_f32_32x32x16_bf16 v[96:111], v[216:219], v[36:39], v[96:111]
    s_waitcnt lgkmcnt(10)
    v_mfma_f32_32x32x16_bf16 v[112:127], v[220:223], v[36:39], v[112:127]
    ds_read_b128 v[36:39], v25 offset:64
    ds_read_b64_tr_b16 v[216:217], v92 offset:32768
    ds_read_b64_tr_b16 v[218:219], v93 offset:32768
    ds_read_b64_tr_b16 v[220:221], v94 offset:32768
    ds_read_b64_tr_b16 v[222:223], v95 offset:32768
    s_waitcnt lgkmcnt(12)
    v_mfma_f32_32x32x16_bf16 v[128:143], v[224:227], v[40:43], 0
    s_waitcnt lgkmcnt(10)
    v_mfma_f32_32x32x16_bf16 v[144:159], v[228:231], v[40:43], 0
    ds_read_b128 v[40:43], v25 offset:96
    ds_read_b64_tr_b16 v[224:225], v92 offset:49152
    ds_read_b64_tr_b16 v[226:227], v93 offset:49152
    ds_read_b64_tr_b16 v[228:229], v94 offset:49152
    ds_read_b64_tr_b16 v[230:231], v95 offset:49152
    s_waitcnt lgkmcnt(12)
    v_mfma_f32_32x32x16_bf16 v[128:143], v[208:211], v[32:35], v[128:143]
    v_cvt_pk_bf16_f32 v176, v96, v97
    v_cvt_pk_bf16_f32 v177, v98, v99
    ds_write_b64 v27, v[176:177] offset:0
    v_cvt_pk_bf16_f32 v178, v100, v101
    v_cvt_pk_bf16_f32 v179, v102, v103
    ds_write_b64 v27, v[178:179] offset:16
    s_waitcnt lgkmcnt(12)
    v_mfma_f32_32x32x16_bf16 v[144:159], v[212:215], v[32:35], v[144:159]
    v_cvt_pk_bf16_f32 v180, v104, v105
    v_cvt_pk_bf16_f32 v181, v106, v107
    ds_write_b64 v27, v[180:181] offset:32
    v_cvt_pk_bf16_f32 v182, v108, v109
    v_cvt_pk_bf16_f32 v183, v110, v111
    ds_write_b64 v27, v[182:183] offset:48
    v_add_u32 v92, 0x10000, v92
    v_add_u32 v93, 0x10000, v93
    v_add_u32 v94, 0x10000, v94
    v_add_u32 v95, 0x10000, v95
    ds_read_b128 v[32:35], v25 offset:128
    ds_read_b64_tr_b16 v[208:209], v92 offset:0
    ds_read_b64_tr_b16 v[210:211], v93 offset:0
    ds_read_b64_tr_b16 v[212:213], v94 offset:0
    ds_read_b64_tr_b16 v[214:215], v95 offset:0
    s_waitcnt lgkmcnt(15)
    v_mfma_f32_32x32x16_bf16 v[128:143], v[216:219], v[36:39], v[128:143]
    v_cvt_pk_bf16_f32 v184, v112, v113
    v_cvt_pk_bf16_f32 v185, v114, v115
    ds_write_b64 v27, v[184:185] offset:64
    v_cvt_pk_bf16_f32 v186, v116, v117
    v_cvt_pk_bf16_f32 v187, v118, v119
    ds_write_b64 v27, v[186:187] offset:80
    s_waitcnt lgkmcnt(15)
    v_mfma_f32_32x32x16_bf16 v[144:159], v[220:223], v[36:39], v[144:159]
    v_cvt_pk_bf16_f32 v188, v120, v121
    v_cvt_pk_bf16_f32 v189, v122, v123
    ds_write_b64 v27, v[188:189] offset:96
    v_cvt_pk_bf16_f32 v190, v124, v125
    v_cvt_pk_bf16_f32 v191, v126, v127
    ds_write_b64 v27, v[190:191] offset:112
    ds_read_b128 v[36:39], v25 offset:160
    ds_read_b64_tr_b16 v[216:217], v92 offset:16384
    ds_read_b64_tr_b16 v[218:219], v93 offset:16384
    ds_read_b64_tr_b16 v[220:221], v94 offset:16384
    ds_read_b64_tr_b16 v[222:223], v95 offset:16384
    s_waitcnt lgkmcnt(15)
    v_mfma_f32_32x32x16_bf16 v[128:143], v[224:227], v[40:43], v[128:143]
    s_waitcnt lgkmcnt(15)
    v_mfma_f32_32x32x16_bf16 v[144:159], v[228:231], v[40:43], v[144:159]
    ds_read_b128 v[40:43], v25 offset:192
    ds_read_b64_tr_b16 v[224:225], v92 offset:32768
    ds_read_b64_tr_b16 v[226:227], v93 offset:32768
    ds_read_b64_tr_b16 v[228:229], v94 offset:32768
    ds_read_b64_tr_b16 v[230:231], v95 offset:32768
    s_waitcnt lgkmcnt(15)
    v_mfma_f32_32x32x16_bf16 v[128:143], v[208:211], v[32:35], v[128:143]
    s_waitcnt lgkmcnt(10)
    ds_read_b128 v[192:195], v28 offset:0
    ds_read_b128 v[196:199], v28 offset:1152
    s_waitcnt lgkmcnt(15)
    v_mfma_f32_32x32x16_bf16 v[144:159], v[212:215], v[32:35], v[144:159]
    ds_read_b128 v[200:203], v28 offset:2304
    ds_read_b128 v[204:207], v28 offset:3456
    ds_read_b128 v[32:35], v25 offset:224
    ds_read_b64_tr_b16 v[208:209], v92 offset:49152
    ds_read_b64_tr_b16 v[210:211], v93 offset:49152
    ds_read_b64_tr_b16 v[212:213], v94 offset:49152
    ds_read_b64_tr_b16 v[214:215], v95 offset:49152
    s_waitcnt lgkmcnt(15)
    v_mfma_f32_32x32x16_bf16 v[128:143], v[216:219], v[36:39], v[128:143]
    s_waitcnt lgkmcnt(14)
    v_mfma_f32_32x32x16_bf16 v[144:159], v[220:223], v[36:39], v[144:159]
    s_waitcnt lgkmcnt(11)
    v_mfma_f32_32x32x16_bf16 v[128:143], v[224:227], v[40:43], v[128:143]
    s_waitcnt lgkmcnt(8)
    buffer_store_dwordx4 v[192:195], v29, s[68:71], s32 offen offset:0 sc1
    s_waitcnt lgkmcnt(7)
    buffer_store_dwordx4 v[196:199], v29, s[68:71], s33 offen offset:0 sc1
    s_waitcnt lgkmcnt(9)
    v_mfma_f32_32x32x16_bf16 v[144:159], v[228:231], v[40:43], v[144:159]
    s_waitcnt lgkmcnt(6)
    buffer_store_dwordx4 v[200:203], v29, s[68:71], s34 offen offset:0 sc1
    s_waitcnt lgkmcnt(5)
    buffer_store_dwordx4 v[204:207], v29, s[68:71], s35 offen offset:0 sc1
    s_waitcnt lgkmcnt(2)
    v_mfma_f32_32x32x16_bf16 v[128:143], v[208:211], v[32:35], v[128:143]
    s_waitcnt lgkmcnt(0)
    v_mfma_f32_32x32x16_bf16 v[144:159], v[212:215], v[32:35], v[144:159]
    v_add_f32 v22, v56, v57
    v_add_f32 v58, v58, v59
    v_add_f32 v22, v22, v58
    s_nop 7
    v_cvt_pk_bf16_f32 v176, v128, v129
    v_cvt_pk_bf16_f32 v177, v130, v131
    ds_write_b64 v27, v[176:177] offset:0
    v_cvt_pk_bf16_f32 v178, v132, v133
    v_cvt_pk_bf16_f32 v179, v134, v135
    ds_write_b64 v27, v[178:179] offset:16
    v_cvt_pk_bf16_f32 v180, v136, v137
    v_cvt_pk_bf16_f32 v181, v138, v139
    ds_write_b64 v27, v[180:181] offset:32
    v_cvt_pk_bf16_f32 v182, v140, v141
    v_cvt_pk_bf16_f32 v183, v142, v143
    ds_write_b64 v27, v[182:183] offset:48
    v_cvt_pk_bf16_f32 v184, v144, v145
    v_cvt_pk_bf16_f32 v185, v146, v147
    ds_write_b64 v27, v[184:185] offset:64
    v_cvt_pk_bf16_f32 v186, v148, v149
    v_cvt_pk_bf16_f32 v187, v150, v151
    ds_write_b64 v27, v[186:187] offset:80
    v_cvt_pk_bf16_f32 v188, v152, v153
    v_cvt_pk_bf16_f32 v189, v154, v155
    ds_write_b64 v27, v[188:189] offset:96
    v_cvt_pk_bf16_f32 v190, v156, v157
    v_cvt_pk_bf16_f32 v191, v158, v159
    ds_write_b64 v27, v[190:191] offset:112
    s_waitcnt lgkmcnt(0)
    ds_read_b128 v[192:195], v28 offset:0
    ds_read_b128 v[196:199], v28 offset:1152
    ds_read_b128 v[200:203], v28 offset:2304
    ds_read_b128 v[204:207], v28 offset:3456
    s_waitcnt lgkmcnt(3)
    buffer_store_dwordx4 v[192:195], v29, s[68:71], s32 offen offset:128 sc1
    s_waitcnt lgkmcnt(2)
    buffer_store_dwordx4 v[196:199], v29, s[68:71], s33 offen offset:128 sc1
    s_waitcnt lgkmcnt(1)
    buffer_store_dwordx4 v[200:203], v29, s[68:71], s34 offen offset:128 sc1
    s_waitcnt lgkmcnt(0)
    buffer_store_dwordx4 v[204:207], v29, s[68:71], s35 offen offset:128 sc1
    s_lshl_b32 s77, s96, 17
    s_lshl_b32 s78, s76, 10
    s_add_u32 s77, s77, s78
    s_lshl_b32 s78, s97, 8
    s_add_u32 s77, s77, s78
    s_lshl_b32 s78, s98, 3
    s_add_u32 s77, s77, s78
    s_add_u32 s77, s77, 25165824
    v_lshlrev_b32 v15, 12, v17
    v_mov_b32 v60, v20
    v_mov_b32 v61, v22
    s_mov_b64 exec, 0xffffffff
    s_waitcnt vmcnt(0)
    buffer_store_dwordx2 v[60:61], v15, s[68:71], s77 offen sc1
    s_mov_b64 exec, -1
    v_mov_b32 v6, 6
    ds_write_b32 v4, v6
    s_lshl_b32 s77, s73, 5
    s_add_u32 s77, s77, s72
    s_lshl_b32 s78, s77, 2
    s_add_u32 s78, s78, s74
    s_lshl_b32 s78, s78, 2
    s_add_u32 s78, s78, s76
    s_lshl_b32 s79, s78, 8
    s_add_u32 s79, s79, 25165824
    s_lshl_b32 s78, s78, 13
    s_add_u32 s78, s78, 1048576
    v_lshlrev_b32 v16, 11, v3
    v_lshl_add_u32 v16, v2, 4, v16
    v_lshlrev_b32 v15, 5, v3
    v_and_b32 v17, 31, v1
    v_lshlrev_b32 v17, 3, v17
    s_waitcnt vmcnt(0)
L_st_18:
    buffer_load_dwordx2 v[112:113], v17, s[68:71], s79 offen sc1
    s_waitcnt vmcnt(0)
    v_max_u32 v6, v112, v113
    v_cmp_eq_u32 vcc, -1, v6
    s_cbranch_vccz L_std_19
    s_sub_u32 s84, s84, 1
    s_cbranch_scc1 L_end
    s_sleep 4
    s_branch L_st_18
L_std_19:
    buffer_load_dwordx4 v[48:51], v16, s[68:71], s78 offen offset:0 sc1
    buffer_load_dwordx4 v[52:55], v16, s[68:71], s78 offen offset:256 sc1
    buffer_load_dwordx4 v[56:59], v16, s[68:71], s78 offen offset:512 sc1
    buffer_load_dwordx4 v[60:63], v16, s[68:71], s78 offen offset:768 sc1
    buffer_load_dwordx4 v[64:67], v16, s[68:71], s78 offen offset:1024 sc1
    buffer_load_dwordx4 v[68:71], v16, s[68:71], s78 offen offset:1280 sc1
    buffer_load_dwordx4 v[72:75], v16, s[68:71], s78 offen offset:1536 sc1
    buffer_load_dwordx4 v[76:79], v16, s[68:71], s78 offen offset:1792 sc1
    ds_bpermute_b32 v80, v15, v112 offset:0
    ds_bpermute_b32 v81, v15, v113 offset:0
    ds_bpermute_b32 v82, v15, v112 offset:4
    ds_bpermute_b32 v83, v15, v113 offset:4
    ds_bpermute_b32 v84, v15, v112 offset:8
    ds_bpermute_b32 v85, v15, v113 offset:8
    ds_bpermute_b32 v86, v15, v112 offset:12
    ds_bpermute_b32 v87, v15, v113 offset:12
    ds_bpermute_b32 v88, v15, v112 offset:16
    ds_bpermute_b32 v89, v15, v113 offset:16
    ds_bpermute_b32 v90, v15, v112 offset:20
    ds_bpermute_b32 v91, v15, v113 offset:20
    ds_bpermute_b32 v92, v15, v112 offset:24
    ds_bpermute_b32 v93, v15, v113 offset:24
    ds_bpermute_b32 v94, v15, v112 offset:28
    ds_bpermute_b32 v95, v15, v113 offset:28
    s_waitcnt lgkmcnt(0)
    v_max3_f32 v20, v80, v82, v84
    v_max3_f32 v20, v20, v86, v88
    v_max3_f32 v20, v20, v90, v92
    v_max_f32 v20, v20, v94
    v_mov_b32 v21, v20
    s_nop 1
    v_permlane32_swap_b32 v20, v21
    v_max_f32 v20, v20, v21
    v_mov_b32 v21, v20
    s_nop 1
    v_permlane16_swap_b32 v20, v21
    v_max_f32 v20, v20, v21
    v_sub_f32 v80, v80, v20
    v_sub_f32 v82, v82, v20
    v_sub_f32 v84, v84, v20
    v_sub_f32 v86, v86, v20
    v_sub_f32 v88, v88, v20
    v_sub_f32 v90, v90, v20
    v_sub_f32 v92, v92, v20
    v_sub_f32 v94, v94, v20
    v_exp_f32 v80, v80
    v_exp_f32 v82, v82
    v_exp_f32 v84, v84
    v_exp_f32 v86, v86
    v_exp_f32 v88, v88
    v_exp_f32 v90, v90
    v_exp_f32 v92, v92
    v_exp_f32 v94, v94
    s_nop 0
    v_mul_f32 v22, v80, v81
    v_fmac_f32 v22, v82, v83
    v_fmac_f32 v22, v84, v85
    v_fmac_f32 v22, v86, v87
    v_fmac_f32 v22, v88, v89
    v_fmac_f32 v22, v90, v91
    v_fmac_f32 v22, v92, v93
    v_fmac_f32 v22, v94, v95
    v_mov_b32 v21, v22
    s_nop 1
    v_permlane32_swap_b32 v22, v21
    v_add_f32 v22, v22, v21
    v_mov_b32 v21, v22
    s_nop 1
    v_permlane16_swap_b32 v22, v21
    v_add_f32 v22, v22, v21
    v_rcp_f32 v243, v22
    s_nop 0
    v_mul_f32 v80, v80, v243
    v_mul_f32 v82, v82, v243
    v_mul_f32 v84, v84, v243
    v_mul_f32 v86, v86, v243
    v_mul_f32 v88, v88, v243
    v_mul_f32 v90, v90, v243
    v_mul_f32 v92, v92, v243
    v_mul_f32 v94, v94, v243
    s_waitcnt vmcnt(7)
    v_lshlrev_b32 v104, 16, v48
    v_and_b32 v105, 0xffff0000, v48
    v_lshlrev_b32 v106, 16, v49
    v_and_b32 v107, 0xffff0000, v49
    v_lshlrev_b32 v108, 16, v50
    v_and_b32 v109, 0xffff0000, v50
    v_lshlrev_b32 v110, 16, v51
    v_and_b32 v111, 0xffff0000, v51
    v_mul_f32 v96, v104, v80
    v_mul_f32 v97, v105, v80
    v_mul_f32 v98, v106, v80
    v_mul_f32 v99, v107, v80
    v_mul_f32 v100, v108, v80
    v_mul_f32 v101, v109, v80
    v_mul_f32 v102, v110, v80
    v_mul_f32 v103, v111, v80
    s_waitcnt vmcnt(6)
    v_lshlrev_b32 v104, 16, v52
    v_and_b32 v105, 0xffff0000, v52
    v_lshlrev_b32 v106, 16, v53
    v_and_b32 v107, 0xffff0000, v53
    v_lshlrev_b32 v108, 16, v54
    v_and_b32 v109, 0xffff0000, v54
    v_lshlrev_b32 v110, 16, v55
    v_and_b32 v111, 0xffff0000, v55
    v_fmac_f32 v96, v104, v82
    v_fmac_f32 v97, v105, v82
    v_fmac_f32 v98, v106, v82
    v_fmac_f32 v99, v107, v82
    v_fmac_f32 v100, v108, v82
    v_fmac_f32 v101, v109, v82
    v_fmac_f32 v102, v110, v82
    v_fmac_f32 v103, v111, v82
    s_waitcnt vmcnt(5)
    v_lshlrev_b32 v104, 16, v56
    v_and_b32 v105, 0xffff0000, v56
    v_lshlrev_b32 v106, 16, v57
    v_and_b32 v107, 0xffff0000, v57
    v_lshlrev_b32 v108, 16, v58
    v_and_b32 v109, 0xffff0000, v58
    v_lshlrev_b32 v110, 16, v59
    v_and_b32 v111, 0xffff0000, v59
    v_fmac_f32 v96, v104, v84
    v_fmac_f32 v97, v105, v84
    v_fmac_f32 v98, v106, v84
    v_fmac_f32 v99, v107, v84
    v_fmac_f32 v100, v108, v84
    v_fmac_f32 v101, v109, v84
    v_fmac_f32 v102, v110, v84
    v_fmac_f32 v103, v111, v84
    s_waitcnt vmcnt(4)
    v_lshlrev_b32 v104, 16, v60
    v_and_b32 v105, 0xffff0000, v60
    v_lshlrev_b32 v106, 16, v61
    v_and_b32 v107, 0xffff0000, v61
    v_lshlrev_b32 v108, 16, v62
    v_and_b32 v109, 0xffff0000, v62
    v_lshlrev_b32 v110, 16, v63
    v_and_b32 v111, 0xffff0000, v63
    v_fmac_f32 v96, v104, v86
    v_fmac_f32 v97, v105, v86
    v_fmac_f32 v98, v106, v86
    v_fmac_f32 v99, v107, v86
    v_fmac_f32 v100, v108, v86
    v_fmac_f32 v101, v109, v86
    v_fmac_f32 v102, v110, v86
    v_fmac_f32 v103, v111, v86
    s_waitcnt vmcnt(3)
    v_lshlrev_b32 v104, 16, v64
    v_and_b32 v105, 0xffff0000, v64
    v_lshlrev_b32 v106, 16, v65
    v_and_b32 v107, 0xffff0000, v65
    v_lshlrev_b32 v108, 16, v66
    v_and_b32 v109, 0xffff0000, v66
    v_lshlrev_b32 v110, 16, v67
    v_and_b32 v111, 0xffff0000, v67
    v_fmac_f32 v96, v104, v88
    v_fmac_f32 v97, v105, v88
    v_fmac_f32 v98, v106, v88
    v_fmac_f32 v99, v107, v88
    v_fmac_f32 v100, v108, v88
    v_fmac_f32 v101, v109, v88
    v_fmac_f32 v102, v110, v88
    v_fmac_f32 v103, v111, v88
    s_waitcnt vmcnt(2)
    v_lshlrev_b32 v104, 16, v68
    v_and_b32 v105, 0xffff0000, v68
    v_lshlrev_b32 v106, 16, v69
    v_and_b32 v107, 0xffff0000, v69
    v_lshlrev_b32 v108, 16, v70
    v_and_b32 v109, 0xffff0000, v70
    v_lshlrev_b32 v110, 16, v71
    v_and_b32 v111, 0xffff0000, v71
    v_fmac_f32 v96, v104, v90
    v_fmac_f32 v97, v105, v90
    v_fmac_f32 v98, v106, v90
    v_fmac_f32 v99, v107, v90
    v_fmac_f32 v100, v108, v90
    v_fmac_f32 v101, v109, v90
    v_fmac_f32 v102, v110, v90
    v_fmac_f32 v103, v111, v90
    s_waitcnt vmcnt(1)
    v_lshlrev_b32 v104, 16, v72
    v_and_b32 v105, 0xffff0000, v72
    v_lshlrev_b32 v106, 16, v73
    v_and_b32 v107, 0xffff0000, v73
    v_lshlrev_b32 v108, 16, v74
    v_and_b32 v109, 0xffff0000, v74
    v_lshlrev_b32 v110, 16, v75
    v_and_b32 v111, 0xffff0000, v75
    v_fmac_f32 v96, v104, v92
    v_fmac_f32 v97, v105, v92
    v_fmac_f32 v98, v106, v92
    v_fmac_f32 v99, v107, v92
    v_fmac_f32 v100, v108, v92
    v_fmac_f32 v101, v109, v92
    v_fmac_f32 v102, v110, v92
    v_fmac_f32 v103, v111, v92
    s_waitcnt vmcnt(0)
    v_lshlrev_b32 v104, 16, v76
    v_and_b32 v105, 0xffff0000, v76
    v_lshlrev_b32 v106, 16, v77
    v_and_b32 v107, 0xffff0000, v77
    v_lshlrev_b32 v108, 16, v78
    v_and_b32 v109, 0xffff0000, v78
    v_lshlrev_b32 v110, 16, v79
    v_and_b32 v111, 0xffff0000, v79
    v_fmac_f32 v96, v104, v94
    v_fmac_f32 v97, v105, v94
    v_fmac_f32 v98, v106, v94
    v_fmac_f32 v99, v107, v94
    v_fmac_f32 v100, v108, v94
    v_fmac_f32 v101, v109, v94
    v_fmac_f32 v102, v110, v94
    v_fmac_f32 v103, v111, v94
    s_nop 1
    v_permlane32_swap_b32 v96, v100
    v_permlane32_swap_b32 v97, v101
    v_permlane32_swap_b32 v98, v102
    v_permlane32_swap_b32 v99, v103
    v_add_f32 v96, v96, v100
    v_add_f32 v97, v97, v101
    v_add_f32 v98, v98, v102
    v_add_f32 v99, v99, v103
    s_nop 1
    v_permlane16_swap_b32 v96, v98
    v_permlane16_swap_b32 v97, v99
    v_add_f32 v96, v96, v98
    v_add_f32 v97, v97, v99
    v_cvt_pk_bf16_f32 v96, v96, v97
    s_mul_i32 s77, s76, 272
    v_lshlrev_b32 v15, 4, v2
    v_lshl_add_u32 v15, v3, 2, v15
    v_add_u32 v15, s77, v15
L_sw_20:
    ds_read_b128 v[252:255], v5 offset:0
    s_waitcnt lgkmcnt(0)
    v_min_u32 v252, v252, v253
    v_min3_u32 v252, v252, v254, v255
    s_sub_u32 s84, s84, 1
    s_cbranch_scc1 L_end
    v_readfirstlane_b32 s80, v252
    s_cmp_ge_u32 s80, 6
    s_cbranch_scc0 L_sw_20
    ds_write_b32 v15, v96
    s_waitcnt lgkmcnt(0)
    v_mov_b32 v6, 7
    ds_write_b32 v4, v6
    s_cmp_ge_u32 s76, 1
    s_cbranch_scc1 L_aend_21
    s_lshl_b32 s77, s74, 11
    s_lshl_b32 s78, s73, 10
    s_add_u32 s77, s77, s78
    s_lshl_b32 s78, s72, 5
    s_add_u32 s86, s77, s78
    v_and_b32 v16, 3, v1
    v_lshl_add_u32 v16, v16, 2, v3
    v_lshlrev_b32 v16, 1, v16
L_sw_22:
    ds_read_b128 v[252:255], v5 offset:16
    s_waitcnt lgkmcnt(0)
    v_min_u32 v252, v252, v253
    v_min3_u32 v252, v252, v254, v255
    s_sub_u32 s84, s84, 1
    s_cbranch_scc1 L_end
    v_readfirstlane_b32 s80, v252
    s_cmp_ge_u32 s80, 4
    s_cbranch_scc0 L_sw_22
L_fp_23:
    buffer_load_dwordx4 v[48:51], v13, s[68:71], s90 offen offset:0 sc1
    buffer_load_dwordx4 v[52:55], v13, s[68:71], s90 offen offset:1024 sc1
    buffer_load_dwordx4 v[56:59], v13, s[68:71], s90 offen offset:2048 sc1
    buffer_load_dwordx4 v[60:63], v13, s[68:71], s90 offen offset:3072 sc1
    buffer_load_dwordx4 v[64:67], v13, s[68:71], s91 offen offset:0 sc1
    buffer_load_dwordx4 v[68:71], v13, s[68:71], s91 offen offset:1024 sc1
    buffer_load_dwordx4 v[72:75], v13, s[68:71], s91 offen offset:2048 sc1
    buffer_load_dwordx4 v[76:79], v13, s[68:71], s91 offen offset:3072 sc1
    s_waitcnt vmcnt(7)
    v_max3_u32 v15, v48, v49, v50
    v_max_u32 v15, v15, v51
    s_waitcnt vmcnt(6)
    v_max3_u32 v15, v15, v52, v53
    v_max3_u32 v15, v15, v54, v55
    v_add_f32 v48, v48, v52
    v_add_f32 v49, v49, v53
    v_add_f32 v50, v50, v54
    v_add_f32 v51, v51, v55
    s_waitcnt vmcnt(5)
    v_max3_u32 v15, v15, v56, v57
    v_max3_u32 v15, v15, v58, v59
    v_add_f32 v48, v48, v56
    v_add_f32 v49, v49, v57
    v_add_f32 v50, v50, v58
    v_add_f32 v51, v51, v59
    s_waitcnt vmcnt(4)
    v_max3_u32 v15, v15, v60, v61
    v_max3_u32 v15, v15, v62, v63
    v_add_f32 v48, v48, v60
    v_add_f32 v49, v49, v61
    v_add_f32 v50, v50, v62
    v_add_f32 v51, v51, v63
    s_waitcnt vmcnt(3)
    v_max3_u32 v15, v15, v64, v65
    v_max3_u32 v15, v15, v66, v67
    v_add_f32 v48, v48, v64
    v_add_f32 v49, v49, v65
    v_add_f32 v50, v50, v66
    v_add_f32 v51, v51, v67
    s_waitcnt vmcnt(2)
    v_max3_u32 v15, v15, v68, v69
    v_max3_u32 v15, v15, v70, v71
    v_add_f32 v48, v48, v68
    v_add_f32 v49, v49, v69
    v_add_f32 v50, v50, v70
    v_add_f32 v51, v51, v71
    s_waitcnt vmcnt(1)
    v_max3_u32 v15, v15, v72, v73
    v_max3_u32 v15, v15, v74, v75
    v_add_f32 v48, v48, v72
    v_add_f32 v49, v49, v73
    v_add_f32 v50, v50, v74
    v_add_f32 v51, v51, v75
    s_waitcnt vmcnt(0)
    v_max3_u32 v15, v15, v76, v77
    v_max3_u32 v15, v15, v78, v79
    v_add_f32 v48, v48, v76
    v_add_f32 v49, v49, v77
    v_add_f32 v50, v50, v78
    v_add_f32 v51, v51, v79
    v_cmp_eq_u32 vcc, -1, v15
    s_cbranch_vccz L_fpd_24
    s_sub_u32 s84, s84, 1
    s_cbranch_scc1 L_end
    s_sleep 2
    s_branch L_fp_23
L_fpd_24:
    v_add_f32_dpp v48, v48, v48 row_ror:8 row_mask:0xf bank_mask:0xf
    v_add_f32_dpp v49, v49, v49 row_ror:8 row_mask:0xf bank_mask:0xf
    v_add_f32_dpp v50, v50, v50 row_ror:8 row_mask:0xf bank_mask:0xf
    v_add_f32_dpp v51, v51, v51 row_ror:8 row_mask:0xf bank_mask:0xf
    v_add_f32_dpp v48, v48, v48 row_ror:4 row_mask:0xf bank_mask:0xf
    v_add_f32_dpp v49, v49, v49 row_ror:4 row_mask:0xf bank_mask:0xf
    v_add_f32_dpp v50, v50, v50 row_ror:4 row_mask:0xf bank_mask:0xf
    v_add_f32_dpp v51, v51, v51 row_ror:4 row_mask:0xf bank_mask:0xf
    s_nop 1
    v_permlane32_swap_b32 v48, v50
    v_permlane32_swap_b32 v49, v51
    v_add_f32 v48, v48, v50
    v_add_f32 v49, v49, v51
    s_nop 1
    v_permlane16_swap_b32 v48, v49
    v_add_f32 v48, v48, v49
    v_cvt_pk_bf16_f32 v48, v48, v48
    s_mov_b32 exec_lo, 0x000f000f
    s_mov_b32 exec_hi, 0x000f000f
    buffer_store_short v48, v16, s[60:63], s86 offen
    s_mov_b64 exec, -1
L_aend_21:
    s_endpgm
L_B:
    v_lshlrev_b32 v13, 4, v1
    s_lshl_b32 s86, s97, 22
    s_lshl_b32 s77, s98, 17
    s_add_u32 s86, s86, s77
    s_lshl_b32 s87, s76, 15
    s_add_u32 s86, s86, s87
    v_lshlrev_b32 v9, 16, v3
    v_lshl_add_u32 v9, v2, 4, v9
    s_lshl_b32 s77, s76, 18
    v_add_u32 v9, s77, v9
    s_lshl_b32 s88, s74, 20
    s_lshl_b32 s77, s72, 8
    s_add_u32 s88, s88, s77
    v_lshlrev_b32 v10, 13, v3
    v_lshl_add_u32 v10, v2, 4, v10
    s_lshl_b32 s77, s76, 8
    v_add_u32 v10, s77, v10
    s_lshl_b32 s78, s72, 17
    s_mov_b32 s77, 0
    s_and_b32 s77, s77, 3
    s_lshl_b32 s90, s77, 15
    s_add_u32 s90, s90, s78
    s_mov_b32 s77, 1
    s_and_b32 s77, s77, 3
    s_lshl_b32 s91, s77, 15
    s_add_u32 s91, s91, s78
    s_mov_b32 s77, 2
    s_and_b32 s77, s77, 3
    s_lshl_b32 s92, s77, 15
    s_add_u32 s92, s92, s78
    s_mov_b32 s77, 3
    s_and_b32 s77, s77, 3
    s_lshl_b32 s93, s77, 15
    s_add_u32 s93, s93, s78
    v_mov_b32 v15, 0
    s_cmp_lg_u32 s76, 3
    s_cbranch_scc1 L_nopf_25
    v_mov_b32 v248, -1
    v_mov_b32 v249, -1
    v_mov_b32 v250, -1
    v_mov_b32 v251, -1
    s_lshl_b32 s77, s73, 7
    s_lshl_b32 s78, s74, 5
    s_add_u32 s77, s77, s78
    s_add_u32 s77, s77, s72
    v_mov_b32 v15, s77
    s_lshl_b32 s77, s77, 13
    s_add_u32 s77, s77, 16777216
    s_add_u32 s78, s77, 4096
    buffer_store_dwordx4 v[248:251], v13, s[68:71], s77 offen offset:0 sc1
    buffer_store_dwordx4 v[248:251], v13, s[68:71], s77 offen offset:1024 sc1
    buffer_store_dwordx4 v[248:251], v13, s[68:71], s77 offen offset:2048 sc1
    buffer_store_dwordx4 v[248:251], v13, s[68:71], s77 offen offset:3072 sc1
    buffer_store_dwordx4 v[248:251], v13, s[68:71], s78 offen offset:0 sc1
    buffer_store_dwordx4 v[248:251], v13, s[68:71], s78 offen offset:1024 sc1
    buffer_store_dwordx4 v[248:251], v13, s[68:71], s78 offen offset:2048 sc1
    buffer_store_dwordx4 v[248:251], v13, s[68:71], s78 offen offset:3072 sc1
    s_lshl_b32 s77, s73, 5
    s_add_u32 s77, s77, s72
    s_lshl_b32 s77, s77, 2
    s_add_u32 s77, s77, s74
    s_lshl_b32 s77, s77, 10
    s_add_u32 s77, s77, 25165824
    s_add_u32 s78, s77, 512
    v_lshlrev_b32 v16, 3, v1
    buffer_store_dwordx2 v[248:249], v16, s[68:71], s77 offen sc1
    buffer_store_dwordx2 v[248:249], v16, s[68:71], s78 offen sc1
    s_waitcnt vmcnt(0)
    v_mov_b32 v6, 1
    ds_write_b32 v5, v6 offset:36
L_nopf_25:
L_sw_26:
    ds_read_b128 v[252:255], v5 offset:0
    s_waitcnt lgkmcnt(0)
    v_min_u32 v252, v252, v253
    v_min3_u32 v252, v252, v254, v255
    s_sub_u32 s84, s84, 1
    s_cbranch_scc1 L_end
    v_readfirstlane_b32 s80, v252
    s_cmp_ge_u32 s80, 1
    s_cbranch_scc0 L_sw_26
    s_add_u32 m0, s87, 0
    s_add_u32 s77, s86, 0
    v_xor_b32 v6, 0, v13
    buffer_load_dwordx4 v6, s[40:43], s77 offen  lds
    s_add_u32 m0, s87, 1024
    s_add_u32 s77, s86, 1024
    v_xor_b32 v6, 64, v13
    buffer_load_dwordx4 v6, s[40:43], s77 offen  lds
    s_add_u32 m0, s87, 2048
    s_add_u32 s77, s86, 2048
    v_xor_b32 v6, 128, v13
    buffer_load_dwordx4 v6, s[40:43], s77 offen  lds
    s_add_u32 m0, s87, 3072
    s_add_u32 s77, s86, 3072
    v_xor_b32 v6, 192, v13
    buffer_load_dwordx4 v6, s[40:43], s77 offen  lds
    s_waitcnt vmcnt(3)
    s_add_u32 m0, s87, 4096
    s_add_u32 s77, s86, 4096
    v_xor_b32 v6, 16, v13
    buffer_load_dwordx4 v6, s[40:43], s77 offen  lds
    s_waitcnt vmcnt(3)
    s_add_u32 m0, s87, 5120
    s_add_u32 s77, s86, 5120
    v_xor_b32 v6, 80, v13
    buffer_load_dwordx4 v6, s[40:43], s77 offen  lds
    s_waitcnt vmcnt(3)
    s_add_u32 m0, s87, 6144
    s_add_u32 s77, s86, 6144
    v_xor_b32 v6, 144, v13
    buffer_load_dwordx4 v6, s[40:43], s77 offen  lds
    s_waitcnt vmcnt(3)
    s_add_u32 m0, s87, 7168
    s_add_u32 s77, s86, 7168
    v_xor_b32 v6, 208, v13
    buffer_load_dwordx4 v6, s[40:43], s77 offen  lds
    s_waitcnt vmcnt(3)
    s_add_u32 m0, s87, 8192
    s_add_u32 s77, s86, 8192
    v_xor_b32 v6, 32, v13
    buffer_load_dwordx4 v6, s[40:43], s77 offen  lds
    s_waitcnt vmcnt(3)
    s_add_u32 m0, s87, 9216
    s_add_u32 s77, s86, 9216
    v_xor_b32 v6, 96, v13
    buffer_load_dwordx4 v6, s[40:43], s77 offen  lds
    s_waitcnt vmcnt(3)
    s_add_u32 m0, s87, 10240
    s_add_u32 s77, s86, 10240
    v_xor_b32 v6, 160, v13
    buffer_load_dwordx4 v6, s[40:43], s77 offen  lds
    s_waitcnt vmcnt(3)
    s_add_u32 m0, s87, 11264
    s_add_u32 s77, s86, 11264
    v_xor_b32 v6, 224, v13
    buffer_load_dwordx4 v6, s[40:43], s77 offen  lds
    s_waitcnt vmcnt(3)
    s_add_u32 m0, s87, 12288
    s_add_u32 s77, s86, 12288
    v_xor_b32 v6, 48, v13
    buffer_load_dwordx4 v6, s[40:43], s77 offen  lds
    s_waitcnt vmcnt(3)
    s_add_u32 m0, s87, 13312
    s_add_u32 s77, s86, 13312
    v_xor_b32 v6, 112, v13
    buffer_load_dwordx4 v6, s[40:43], s77 offen  lds
    s_waitcnt vmcnt(3)
    s_add_u32 m0, s87, 14336
    s_add_u32 s77, s86, 14336
    v_xor_b32 v6, 176, v13
    buffer_load_dwordx4 v6, s[40:43], s77 offen  lds
    s_waitcnt vmcnt(3)
    s_add_u32 m0, s87, 15360
    s_add_u32 s77, s86, 15360
    v_xor_b32 v6, 240, v13
    buffer_load_dwordx4 v6, s[40:43], s77 offen  lds
    s_waitcnt vmcnt(3)
    s_add_u32 m0, s87, 16384
    s_add_u32 s77, s86, 16384
    v_xor_b32 v6, 0, v13
    buffer_load_dwordx4 v6, s[40:43], s77 offen  lds
    s_waitcnt vmcnt(3)
    s_add_u32 m0, s87, 17408
    s_add_u32 s77, s86, 17408
    v_xor_b32 v6, 64, v13
    buffer_load_dwordx4 v6, s[40:43], s77 offen  lds
    s_waitcnt vmcnt(3)
    s_add_u32 m0, s87, 18432
    s_add_u32 s77, s86, 18432
    v_xor_b32 v6, 128, v13
    buffer_load_dwordx4 v6, s[40:43], s77 offen  lds
    s_waitcnt vmcnt(3)
    s_add_u32 m0, s87, 19456
    s_add_u32 s77, s86, 19456
    v_xor_b32 v6, 192, v13
    buffer_load_dwordx4 v6, s[40:43], s77 offen  lds
    s_waitcnt vmcnt(3)
    s_add_u32 m0, s87, 20480
    s_add_u32 s77, s86, 20480
    v_xor_b32 v6, 16, v13
    buffer_load_dwordx4 v6, s[40:43], s77 offen  lds
    s_waitcnt vmcnt(3)
    v_mov_b32 v6, 1
    ds_write_b32 v4, v6
    s_add_u32 m0, s87, 21504
    s_add_u32 s77, s86, 21504
    v_xor_b32 v6, 80, v13
    buffer_load_dwordx4 v6, s[40:43], s77 offen  lds
    s_waitcnt vmcnt(3)
    s_add_u32 m0, s87, 22528
    s_add_u32 s77, s86, 22528
    v_xor_b32 v6, 144, v13
    buffer_load_dwordx4 v6, s[40:43], s77 offen  lds
    s_waitcnt vmcnt(3)
    s_add_u32 m0, s87, 23552
    s_add_u32 s77, s86, 23552
    v_xor_b32 v6, 208, v13
    buffer_load_dwordx4 v6, s[40:43], s77 offen  lds
    s_waitcnt vmcnt(3)
    s_add_u32 m0, s87, 24576
    s_add_u32 s77, s86, 24576
    v_xor_b32 v6, 32, v13
    buffer_load_dwordx4 v6, s[40:43], s77 offen  lds
    s_waitcnt vmcnt(3)
    s_add_u32 m0, s87, 25600
    s_add_u32 s77, s86, 25600
    v_xor_b32 v6, 96, v13
    buffer_load_dwordx4 v6, s[40:43], s77 offen  lds
    s_waitcnt vmcnt(3)
    s_add_u32 m0, s87, 26624
    s_add_u32 s77, s86, 26624
    v_xor_b32 v6, 160, v13
    buffer_load_dwordx4 v6, s[40:43], s77 offen  lds
    s_waitcnt vmcnt(3)
    s_add_u32 m0, s87, 27648
    s_add_u32 s77, s86, 27648
    v_xor_b32 v6, 224, v13
    buffer_load_dwordx4 v6, s[40:43], s77 offen  lds
    s_waitcnt vmcnt(3)
    s_add_u32 m0, s87, 28672
    s_add_u32 s77, s86, 28672
    v_xor_b32 v6, 48, v13
    buffer_load_dwordx4 v6, s[40:43], s77 offen  lds
    s_waitcnt vmcnt(3)
    s_add_u32 m0, s87, 29696
    s_add_u32 s77, s86, 29696
    v_xor_b32 v6, 112, v13
    buffer_load_dwordx4 v6, s[40:43], s77 offen  lds
    s_waitcnt vmcnt(3)
    s_add_u32 m0, s87, 30720
    s_add_u32 s77, s86, 30720
    v_xor_b32 v6, 176, v13
    buffer_load_dwordx4 v6, s[40:43], s77 offen  lds
    s_waitcnt vmcnt(3)
    s_add_u32 m0, s87, 31744
    s_add_u32 s77, s86, 31744
    v_xor_b32 v6, 240, v13
    buffer_load_dwordx4 v6, s[40:43], s77 offen  lds
    s_waitcnt vmcnt(3)
    s_waitcnt vmcnt(0)
    v_mov_b32 v6, 2
    ds_write_b32 v4, v6
L_sw_27:
    ds_read_b128 v[252:255], v5 offset:16
    s_waitcnt lgkmcnt(0)
    v_min_u32 v252, v252, v253
    v_min3_u32 v252, v252, v254, v255
    s_sub_u32 s84, s84, 1
    s_cbranch_scc1 L_end
    v_readfirstlane_b32 s80, v252
    s_cmp_ge_u32 s80, 2
    s_cbranch_scc0 L_sw_27
    s_add_u32 s77, s88, 0
    buffer_load_dwordx4 v[64:67], v9, s[52:55], s77 offen
    s_waitcnt vmcnt(7)
    s_add_u32 s77, s88, 8192
    buffer_load_dwordx4 v[68:71], v9, s[52:55], s77 offen
    s_waitcnt vmcnt(7)
    s_add_u32 s77, s88, 16384
    buffer_load_dwordx4 v[72:75], v9, s[52:55], s77 offen
    s_waitcnt vmcnt(7)
    s_add_u32 s77, s88, 24576
    buffer_load_dwordx4 v[76:79], v9, s[52:55], s77 offen
    s_waitcnt vmcnt(7)
    s_add_u32 s77, s88, 32768
    buffer_load_dwordx4 v[80:83], v9, s[52:55], s77 offen
    s_waitcnt vmcnt(7)
    s_add_u32 s77, s88, 40960
    buffer_load_dwordx4 v[84:87], v9, s[52:55], s77 offen
    s_waitcnt vmcnt(7)
    s_add_u32 s77, s88, 49152
    buffer_load_dwordx4 v[88:91], v9, s[52:55], s77 offen
    s_waitcnt vmcnt(7)
    s_add_u32 s77, s88, 57344
    buffer_load_dwordx4 v[92:95], v9, s[52:55], s77 offen
    s_waitcnt vmcnt(7)
    s_add_u32 s77, s90, 0
    buffer_load_dwordx4 v[96:99], v10, s[56:59], s77 offen
    s_waitcnt vmcnt(7)
    s_add_u32 s77, s90, 1024
    buffer_load_dwordx4 v[100:103], v10, s[56:59], s77 offen
    s_waitcnt vmcnt(7)
    s_add_u32 s77, s90, 2048
    buffer_load_dwordx4 v[104:107], v10, s[56:59], s77 offen
    s_waitcnt vmcnt(7)
    s_add_u32 s77, s90, 3072
    buffer_load_dwordx4 v[108:111], v10, s[56:59], s77 offen
    s_waitcnt vmcnt(7)
    s_add_u32 s77, s90, 4096
    buffer_load_dwordx4 v[112:115], v10, s[56:59], s77 offen
    s_waitcnt vmcnt(7)
    s_add_u32 s77, s90, 5120
    buffer_load_dwordx4 v[116:119], v10, s[56:59], s77 offen
    s_waitcnt vmcnt(7)
    s_add_u32 s77, s90, 6144
    buffer_load_dwordx4 v[120:123], v10, s[56:59], s77 offen
    s_waitcnt vmcnt(7)
    v_perm_b32 v32, v68, v64, s81
    v_perm_b32 v33, v76, v72, s81
    v_perm_b32 v34, v84, v80, s81
    v_perm_b32 v35, v92, v88, s81
    v_perm_b32 v36, v68, v64, s82
    v_perm_b32 v37, v76, v72, s82
    v_perm_b32 v38, v84, v80, s82
    v_perm_b32 v39, v92, v88, s82
    v_perm_b32 v40, v69, v65, s81
    v_perm_b32 v41, v77, v73, s81
    v_perm_b32 v42, v85, v81, s81
    v_perm_b32 v43, v93, v89, s81
    v_perm_b32 v44, v69, v65, s82
    v_perm_b32 v45, v77, v73, s82
    v_perm_b32 v46, v85, v81, s82
    v_perm_b32 v47, v93, v89, s82
    v_perm_b32 v48, v70, v66, s81
    v_perm_b32 v49, v78, v74, s81
    v_perm_b32 v50, v86, v82, s81
    v_perm_b32 v51, v94, v90, s81
    v_perm_b32 v52, v70, v66, s82
    v_perm_b32 v53, v78, v74, s82
    v_perm_b32 v54, v86, v82, s82
    v_perm_b32 v55, v94, v90, s82
    v_perm_b32 v56, v71, v67, s81
    v_perm_b32 v57, v79, v75, s81
    v_perm_b32 v58, v87, v83, s81
    v_perm_b32 v59, v95, v91, s81
    v_perm_b32 v60, v71, v67, s82
    v_perm_b32 v61, v79, v75, s82
    v_perm_b32 v62, v87, v83, s82
    v_perm_b32 v63, v95, v91, s82
    s_add_u32 s77, s90, 7168
    buffer_load_dwordx4 v[124:127], v10, s[56:59], s77 offen
    s_waitcnt vmcnt(7)
    s_add_u32 s77, s91, 0
    buffer_load_dwordx4 v[128:131], v10, s[56:59], s77 offen
    s_waitcnt vmcnt(7)
    s_add_u32 s77, s91, 1024
    buffer_load_dwordx4 v[132:135], v10, s[56:59], s77 offen
    s_waitcnt vmcnt(7)
    s_add_u32 s77, s91, 2048
    buffer_load_dwordx4 v[136:139], v10, s[56:59], s77 offen
    s_waitcnt vmcnt(7)
    s_add_u32 s77, s91, 3072
    buffer_load_dwordx4 v[140:143], v10, s[56:59], s77 offen
    s_waitcnt vmcnt(7)
    s_add_u32 s77, s91, 4096
    buffer_load_dwordx4 v[144:147], v10, s[56:59], s77 offen
    s_waitcnt vmcnt(7)
    s_add_u32 s77, s91, 5120
    buffer_load_dwordx4 v[148:151], v10, s[56:59], s77 offen
    s_waitcnt vmcnt(7)
    s_add_u32 s77, s91, 6144
    buffer_load_dwordx4 v[152:155], v10, s[56:59], s77 offen
    s_waitcnt vmcnt(7)
    v_perm_b32 v64, v100, v96, s81
    v_perm_b32 v65, v108, v104, s81
    v_perm_b32 v66, v116, v112, s81
    v_perm_b32 v67, v124, v120, s81
    v_perm_b32 v68, v100, v96, s82
    v_perm_b32 v69, v108, v104, s82
    v_perm_b32 v70, v116, v112, s82
    v_perm_b32 v71, v124, v120, s82
    v_perm_b32 v72, v101, v97, s81
    v_perm_b32 v73, v109, v105, s81
    v_perm_b32 v74, v117, v113, s81
    v_perm_b32 v75, v125, v121, s81
    v_perm_b32 v76, v101, v97, s82
    v_perm_b32 v77, v109, v105, s82
    v_perm_b32 v78, v117, v113, s82
    v_perm_b32 v79, v125, v121, s82
    v_perm_b32 v80, v102, v98, s81
    v_perm_b32 v81, v110, v106, s81
    v_perm_b32 v82, v118, v114, s81
    v_perm_b32 v83, v126, v122, s81
    v_perm_b32 v84, v102, v98, s82
    v_perm_b32 v85, v110, v106, s82
    v_perm_b32 v86, v118, v114, s82
    v_perm_b32 v87, v126, v122, s82
    v_perm_b32 v88, v103, v99, s81
    v_perm_b32 v89, v111, v107, s81
    v_perm_b32 v90, v119, v115, s81
    v_perm_b32 v91, v127, v123, s81
    v_perm_b32 v92, v103, v99, s82
    v_perm_b32 v93, v111, v107, s82
    v_perm_b32 v94, v119, v115, s82
    v_perm_b32 v95, v127, v123, s82
    s_add_u32 s77, s91, 7168
    buffer_load_dwordx4 v[156:159], v10, s[56:59], s77 offen
    s_waitcnt vmcnt(7)
    s_add_u32 s77, s92, 0
    buffer_load_dwordx4 v[160:163], v10, s[56:59], s77 offen
    s_waitcnt vmcnt(7)
    s_add_u32 s77, s92, 1024
    buffer_load_dwordx4 v[164:167], v10, s[56:59], s77 offen
    s_waitcnt vmcnt(7)
    s_add_u32 s77, s92, 2048
    buffer_load_dwordx4 v[168:171], v10, s[56:59], s77 offen
    s_waitcnt vmcnt(7)
    s_add_u32 s77, s92, 3072
    buffer_load_dwordx4 v[172:175], v10, s[56:59], s77 offen
    s_waitcnt vmcnt(7)
    s_add_u32 s77, s92, 4096
    buffer_load_dwordx4 v[176:179], v10, s[56:59], s77 offen
    s_waitcnt vmcnt(7)
    s_add_u32 s77, s92, 5120
    buffer_load_dwordx4 v[180:183], v10, s[56:59], s77 offen
    s_waitcnt vmcnt(7)
    s_add_u32 s77, s92, 6144
    buffer_load_dwordx4 v[184:187], v10, s[56:59], s77 offen
    s_waitcnt vmcnt(7)
    v_perm_b32 v96, v132, v128, s81
    v_perm_b32 v97, v140, v136, s81
    v_perm_b32 v98, v148, v144, s81
    v_perm_b32 v99, v156, v152, s81
    v_perm_b32 v100, v132, v128, s82
    v_perm_b32 v101, v140, v136, s82
    v_perm_b32 v102, v148, v144, s82
    v_perm_b32 v103, v156, v152, s82
    v_perm_b32 v104, v133, v129, s81
    v_perm_b32 v105, v141, v137, s81
    v_perm_b32 v106, v149, v145, s81
    v_perm_b32 v107, v157, v153, s81
    v_perm_b32 v108, v133, v129, s82
    v_perm_b32 v109, v141, v137, s82
    v_perm_b32 v110, v149, v145, s82
    v_perm_b32 v111, v157, v153, s82
    v_perm_b32 v112, v134, v130, s81
    v_perm_b32 v113, v142, v138, s81
    v_perm_b32 v114, v150, v146, s81
    v_perm_b32 v115, v158, v154, s81
    v_perm_b32 v116, v134, v130, s82
    v_perm_b32 v117, v142, v138, s82
    v_perm_b32 v118, v150, v146, s82
    v_perm_b32 v119, v158, v154, s82
    v_perm_b32 v120, v135, v131, s81
    v_perm_b32 v121, v143, v139, s81
    v_perm_b32 v122, v151, v147, s81
    v_perm_b32 v123, v159, v155, s81
    v_perm_b32 v124, v135, v131, s82
    v_perm_b32 v125, v143, v139, s82
    v_perm_b32 v126, v151, v147, s82
    v_perm_b32 v127, v159, v155, s82
    s_add_u32 s77, s92, 7168
    buffer_load_dwordx4 v[188:191], v10, s[56:59], s77 offen
    s_waitcnt vmcnt(7)
    s_add_u32 s77, s93, 0
    buffer_load_dwordx4 v[192:195], v10, s[56:59], s77 offen
    s_waitcnt vmcnt(7)
    s_add_u32 s77, s93, 1024
    buffer_load_dwordx4 v[196:199], v10, s[56:59], s77 offen
    s_waitcnt vmcnt(7)
    s_add_u32 s77, s93, 2048
    buffer_load_dwordx4 v[200:203], v10, s[56:59], s77 offen
    s_waitcnt vmcnt(7)
    s_add_u32 s77, s93, 3072
    buffer_load_dwordx4 v[204:207], v10, s[56:59], s77 offen
    s_waitcnt vmcnt(7)
    s_add_u32 s77, s93, 4096
    buffer_load_dwordx4 v[208:211], v10, s[56:59], s77 offen
    s_waitcnt vmcnt(7)
    s_add_u32 s77, s93, 5120
    buffer_load_dwordx4 v[212:215], v10, s[56:59], s77 offen
    s_waitcnt vmcnt(7)
    s_add_u32 s77, s93, 6144
    buffer_load_dwordx4 v[216:219], v10, s[56:59], s77 offen
    s_waitcnt vmcnt(7)
    v_perm_b32 v128, v164, v160, s81
    v_perm_b32 v129, v172, v168, s81
    v_perm_b32 v130, v180, v176, s81
    v_perm_b32 v131, v188, v184, s81
    v_perm_b32 v132, v164, v160, s82
    v_perm_b32 v133, v172, v168, s82
    v_perm_b32 v134, v180, v176, s82
    v_perm_b32 v135, v188, v184, s82
    v_perm_b32 v136, v165, v161, s81
    v_perm_b32 v137, v173, v169, s81
    v_perm_b32 v138, v181, v177, s81
    v_perm_b32 v139, v189, v185, s81
    v_perm_b32 v140, v165, v161, s82
    v_perm_b32 v141, v173, v169, s82
    v_perm_b32 v142, v181, v177, s82
    v_perm_b32 v143, v189, v185, s82
    v_perm_b32 v144, v166, v162, s81
    v_perm_b32 v145, v174, v170, s81
    v_perm_b32 v146, v182, v178, s81
    v_perm_b32 v147, v190, v186, s81
    v_perm_b32 v148, v166, v162, s82
    v_perm_b32 v149, v174, v170, s82
    v_perm_b32 v150, v182, v178, s82
    v_perm_b32 v151, v190, v186, s82
    v_perm_b32 v152, v167, v163, s81
    v_perm_b32 v153, v175, v171, s81
    v_perm_b32 v154, v183, v179, s81
    v_perm_b32 v155, v191, v187, s81
    v_perm_b32 v156, v167, v163, s82
    v_perm_b32 v157, v175, v171, s82
    v_perm_b32 v158, v183, v179, s82
    v_perm_b32 v159, v191, v187, s82
    s_add_u32 s77, s93, 7168
    buffer_load_dwordx4 v[220:223], v10, s[56:59], s77 offen
    s_waitcnt vmcnt(7)
    s_waitcnt vmcnt(0)
    v_perm_b32 v160, v196, v192, s81
    v_perm_b32 v161, v204, v200, s81
    v_perm_b32 v162, v212, v208, s81
    v_perm_b32 v163, v220, v216, s81
    v_perm_b32 v164, v196, v192, s82
    v_perm_b32 v165, v204, v200, s82
    v_perm_b32 v166, v212, v208, s82
    v_perm_b32 v167, v220, v216, s82
    v_perm_b32 v168, v197, v193, s81
    v_perm_b32 v169, v205, v201, s81
    v_perm_b32 v170, v213, v209, s81
    v_perm_b32 v171, v221, v217, s81
    v_perm_b32 v172, v197, v193, s82
    v_perm_b32 v173, v205, v201, s82
    v_perm_b32 v174, v213, v209, s82
    v_perm_b32 v175, v221, v217, s82
    v_perm_b32 v176, v198, v194, s81
    v_perm_b32 v177, v206, v202, s81
    v_perm_b32 v178, v214, v210, s81
    v_perm_b32 v179, v222, v218, s81
    v_perm_b32 v180, v198, v194, s82
    v_perm_b32 v181, v206, v202, s82
    v_perm_b32 v182, v214, v210, s82
    v_perm_b32 v183, v222, v218, s82
    v_perm_b32 v184, v199, v195, s81
    v_perm_b32 v185, v207, v203, s81
    v_perm_b32 v186, v215, v211, s81
    v_perm_b32 v187, v223, v219, s81
    v_perm_b32 v188, v199, v195, s82
    v_perm_b32 v189, v207, v203, s82
    v_perm_b32 v190, v215, v211, s82
    v_perm_b32 v191, v223, v219, s82
    v_mul_u32_u24 v11, 272, v2
    v_lshl_add_u32 v11, v3, 4, v11
    v_mov_b32 v14, v11
    s_lshl_b32 s77, s76, 6
    v_add_u32 v11, s77, v11
    v_mov_b32 v6, 161856
    v_cmp_gt_u32 vcc, 4, v2
    s_nop 1
    v_cndmask_b32 v11, v6, v11, vcc
    v_add_u32 v14, 4096, v14
    s_mul_i32 s77, s76, 1088
    s_add_u32 s77, s77, 4096
    v_lshlrev_b32 v12, 4, v2
    v_add_u32 v12, s77, v12
    s_mov_b32 s77, 0
    s_and_b32 s77, s77, 3
    s_lshl_b32 s77, s77, 6
    v_add_u32 v16, s77, v14
    s_mov_b32 s77, 1
    s_and_b32 s77, s77, 3
    s_lshl_b32 s77, s77, 6
    v_add_u32 v17, s77, v14
    s_mov_b32 s77, 2
    s_and_b32 s77, s77, 3
    s_lshl_b32 s77, s77, 6
    v_add_u32 v18, s77, v14
    s_mov_b32 s77, 3
    s_and_b32 s77, s77, 3
    s_lshl_b32 s77, s77, 6
    v_add_u32 v19, s77, v14
    v_lshrrev_b32 v6, 1, v2
    v_lshl_add_u32 v6, v3, 5, v6
    v_lshlrev_b32 v20, 13, v6
    v_and_b32 v6, 1, v2
    v_lshl_add_u32 v20, v6, 5, v20
    s_lshl_b32 s77, s73, 20
    s_lshl_b32 s78, s76, 16
    s_add_u32 s77, s77, s78
    s_lshl_b32 s78, s74, 11
    s_add_u32 s77, s77, s78
    s_lshl_b32 s78, s72, 6
    s_add_u32 s77, s77, s78
    s_add_u32 s89, s77, 16777216
L_sw_28:
    ds_read_b128 v[252:255], v5 offset:0
    s_waitcnt lgkmcnt(0)
    v_min_u32 v252, v252, v253
    v_min3_u32 v252, v252, v254, v255
    s_sub_u32 s84, s84, 1
    s_cbranch_scc1 L_end
    v_readfirstlane_b32 s80, v252
    s_cmp_ge_u32 s80, 7
    s_cbranch_scc0 L_sw_28
    ds_read_b128 v[24:27], v11
    s_waitcnt lgkmcnt(0)
    v_mfma_f32_16x16x32_bf16 v[192:195], v[24:27], v[32:35], 0
    v_mfma_f32_16x16x32_bf16 v[196:199], v[24:27], v[36:39], 0
    v_mfma_f32_16x16x32_bf16 v[200:203], v[24:27], v[40:43], 0
    v_mfma_f32_16x16x32_bf16 v[204:207], v[24:27], v[44:47], 0
    v_mfma_f32_16x16x32_bf16 v[208:211], v[24:27], v[48:51], 0
    v_mfma_f32_16x16x32_bf16 v[212:215], v[24:27], v[52:55], 0
    v_mfma_f32_16x16x32_bf16 v[216:219], v[24:27], v[56:59], 0
    v_mfma_f32_16x16x32_bf16 v[220:223], v[24:27], v[60:63], 0
    s_nop 7
    s_mov_b64 exec, 0xffff
    v_cvt_pk_bf16_f32 v224, v192, v196
    v_cvt_pk_bf16_f32 v225, v200, v204
    v_cvt_pk_bf16_f32 v226, v208, v212
    v_cvt_pk_bf16_f32 v227, v216, v220
    ds_write_b128 v12, v[224:227] offset:0
    v_cvt_pk_bf16_f32 v228, v193, v197
    v_cvt_pk_bf16_f32 v229, v201, v205
    v_cvt_pk_bf16_f32 v230, v209, v213
    v_cvt_pk_bf16_f32 v231, v217, v221
    ds_write_b128 v12, v[228:231] offset:272
    v_cvt_pk_bf16_f32 v232, v194, v198
    v_cvt_pk_bf16_f32 v233, v202, v206
    v_cvt_pk_bf16_f32 v234, v210, v214
    v_cvt_pk_bf16_f32 v235, v218, v222
    ds_write_b128 v12, v[232:235] offset:544
    v_cvt_pk_bf16_f32 v236, v195, v199
    v_cvt_pk_bf16_f32 v237, v203, v207
    v_cvt_pk_bf16_f32 v238, v211, v215
    v_cvt_pk_bf16_f32 v239, v219, v223
    ds_write_b128 v12, v[236:239] offset:816
    s_mov_b64 exec, -1
    s_waitcnt lgkmcnt(0)
    v_mov_b32 v6, 3
    ds_write_b32 v4, v6
L_sw_29:
    ds_read_b128 v[252:255], v5 offset:16
    s_waitcnt lgkmcnt(0)
    v_min_u32 v252, v252, v253
    v_min3_u32 v252, v252, v254, v255
    s_sub_u32 s84, s84, 1
    s_cbranch_scc1 L_end
    v_readfirstlane_b32 s80, v252
    s_cmp_ge_u32 s80, 3
    s_cbranch_scc0 L_sw_29
    ds_read_b128 v[224:227], v16
    ds_read_b128 v[228:231], v17
    ds_read_b128 v[232:235], v18
    ds_read_b128 v[236:239], v19
    s_waitcnt lgkmcnt(3)
    v_mfma_f32_16x16x32_bf16 v[192:195], v[224:227], v[64:67], 0
    v_mfma_f32_16x16x32_bf16 v[196:199], v[224:227], v[68:71], 0
    v_mfma_f32_16x16x32_bf16 v[200:203], v[224:227], v[72:75], 0
    v_mfma_f32_16x16x32_bf16 v[204:207], v[224:227], v[76:79], 0
    v_mfma_f32_16x16x32_bf16 v[208:211], v[224:227], v[80:83], 0
    v_mfma_f32_16x16x32_bf16 v[212:215], v[224:227], v[84:87], 0
    v_mfma_f32_16x16x32_bf16 v[216:219], v[224:227], v[88:91], 0
    v_mfma_f32_16x16x32_bf16 v[220:223], v[224:227], v[92:95], 0
    s_waitcnt lgkmcnt(2)
    v_mfma_f32_16x16x32_bf16 v[192:195], v[228:231], v[96:99], v[192:195]
    v_mfma_f32_16x16x32_bf16 v[196:199], v[228:231], v[100:103], v[196:199]
    v_mfma_f32_16x16x32_bf16 v[200:203], v[228:231], v[104:107], v[200:203]
    v_mfma_f32_16x16x32_bf16 v[204:207], v[228:231], v[108:111], v[204:207]
    v_mfma_f32_16x16x32_bf16 v[208:211], v[228:231], v[112:115], v[208:211]
    v_mfma_f32_16x16x32_bf16 v[212:215], v[228:231], v[116:119], v[212:215]
    v_mfma_f32_16x16x32_bf16 v[216:219], v[228:231], v[120:123], v[216:219]
    v_mfma_f32_16x16x32_bf16 v[220:223], v[228:231], v[124:127], v[220:223]
    s_waitcnt lgkmcnt(1)
    v_mfma_f32_16x16x32_bf16 v[192:195], v[232:235], v[128:131], v[192:195]
    v_mfma_f32_16x16x32_bf16 v[196:199], v[232:235], v[132:135], v[196:199]
    v_mfma_f32_16x16x32_bf16 v[200:203], v[232:235], v[136:139], v[200:203]
    v_mfma_f32_16x16x32_bf16 v[204:207], v[232:235], v[140:143], v[204:207]
    v_mfma_f32_16x16x32_bf16 v[208:211], v[232:235], v[144:147], v[208:211]
    v_mfma_f32_16x16x32_bf16 v[212:215], v[232:235], v[148:151], v[212:215]
    v_mfma_f32_16x16x32_bf16 v[216:219], v[232:235], v[152:155], v[216:219]
    v_mfma_f32_16x16x32_bf16 v[220:223], v[232:235], v[156:159], v[220:223]
    s_waitcnt lgkmcnt(0)
    v_mfma_f32_16x16x32_bf16 v[192:195], v[236:239], v[160:163], v[192:195]
    v_mfma_f32_16x16x32_bf16 v[196:199], v[236:239], v[164:167], v[196:199]
    v_mfma_f32_16x16x32_bf16 v[200:203], v[236:239], v[168:171], v[200:203]
    v_mfma_f32_16x16x32_bf16 v[204:207], v[236:239], v[172:175], v[204:207]
    v_mfma_f32_16x16x32_bf16 v[208:211], v[236:239], v[176:179], v[208:211]
    v_mfma_f32_16x16x32_bf16 v[212:215], v[236:239], v[180:183], v[212:215]
    v_mfma_f32_16x16x32_bf16 v[216:219], v[236:239], v[184:187], v[216:219]
    v_mfma_f32_16x16x32_bf16 v[220:223], v[236:239], v[188:191], v[220:223]
    s_nop 7
    v_permlane32_swap_b32 v192, v194
    v_permlane32_swap_b32 v193, v195
    v_permlane32_swap_b32 v196, v198
    v_permlane32_swap_b32 v197, v199
    v_permlane32_swap_b32 v200, v202
    v_permlane32_swap_b32 v201, v203
    v_permlane32_swap_b32 v204, v206
    v_permlane32_swap_b32 v205, v207
    v_permlane32_swap_b32 v208, v210
    v_permlane32_swap_b32 v209, v211
    v_permlane32_swap_b32 v212, v214
    v_permlane32_swap_b32 v213, v215
    v_permlane32_swap_b32 v216, v218
    v_permlane32_swap_b32 v217, v219
    v_permlane32_swap_b32 v220, v222
    v_permlane32_swap_b32 v221, v223
    v_add_f32 v192, v192, v194
    v_add_f32 v193, v193, v195
    v_add_f32 v196, v196, v198
    v_add_f32 v197, v197, v199
    v_add_f32 v200, v200, v202
    v_add_f32 v201, v201, v203
    v_add_f32 v204, v204, v206
    v_add_f32 v205, v205, v207
    v_add_f32 v208, v208, v210
    v_add_f32 v209, v209, v211
    v_add_f32 v212, v212, v214
    v_add_f32 v213, v213, v215
    v_add_f32 v216, v216, v218
    v_add_f32 v217, v217, v219
    v_add_f32 v220, v220, v222
    v_add_f32 v221, v221, v223
    v_permlane16_swap_b32 v192, v193
    v_permlane16_swap_b32 v196, v197
    v_permlane16_swap_b32 v200, v201
    v_permlane16_swap_b32 v204, v205
    v_permlane16_swap_b32 v208, v209
    v_permlane16_swap_b32 v212, v213
    v_permlane16_swap_b32 v216, v217
    v_permlane16_swap_b32 v220, v221
    v_add_f32 v224, v192, v193
    v_add_f32 v225, v196, v197
    v_add_f32 v226, v200, v201
    v_add_f32 v227, v204, v205
    v_add_f32 v228, v208, v209
    v_add_f32 v229, v212, v213
    v_add_f32 v230, v216, v217
    v_add_f32 v231, v220, v221
    buffer_store_dwordx4 v[224:227], v20, s[68:71], s89 offen sc1
    buffer_store_dwordx4 v[228:231], v20, s[68:71], s89 offen offset:16 sc1
    s_waitcnt vmcnt(0)
    v_mov_b32 v6, 4
    ds_write_b32 v4, v6
L_end:
    s_endpgm
.section .rodata,"a"
.p2align 6
.amdhsa_kernel concat_heads__compressed_kv_cla__compressed_kv_cla__decode_kernel
  .amdhsa_next_free_vgpr 256
  .amdhsa_next_free_sgpr 102
  .amdhsa_accum_offset 256
  .amdhsa_group_segment_fixed_size 0
  .amdhsa_kernarg_size 120
  .amdhsa_user_sgpr_count 2
  .amdhsa_user_sgpr_kernarg_segment_ptr 1
  .amdhsa_system_sgpr_workgroup_id_x 1
.end_amdhsa_kernel
```
